```python
import torch

def _softmax(x, axis=-1):
    return torch.softmax(x, dim=axis)
def _gelu(x):
    return torch.nn.functional.gelu(x, approximate="tanh")
def _silu(x):
    return torch.nn.functional.silu(x)
def _sigmoid(x):
    return torch.sigmoid(x)
def _layernorm(x, axis=-1, eps=1e-5):
    m = x.mean(dim=axis, keepdim=True)
    v = x.var(dim=axis, keepdim=True, unbiased=False)
    return (x - m) / torch.sqrt(v + eps)
def _scatter_add(tgt, idx, src, axis=0):
    return tgt.clone().index_add_(axis, idx, src)
def _segment_sum(src, seg, n):
    out = torch.zeros((n,) + src.shape[1:], dtype=src.dtype)
    return out.index_add_(0, seg, src)
def _pad(x, pw):
    flat = tuple(v for pair in reversed(pw) for v in pair)
    return torch.nn.functional.pad(x, flat)

kernel_name = 'gated_mix__sliding_block_cached__gqa_block_cached__decode'

def setup_inputs():

    _w = (lambda a: (lambda t: t.to(torch.bfloat16) if t.is_floating_point() else t)(torch.as_tensor(a)))
    def _A_setup():
        B, Sq, D = 1, 1, 448
        Hq, Hkv, Sk, Dh = 16, 8, 8192, 256
        assert Hq % Hkv == 0, (Hq, Hkv)
        return {
            "x": _w((lambda *s: torch.randn(*s, dtype=torch.bfloat16) * 0.05)(B, Sq, D)),
            "k_cache": _w((lambda *s: torch.randn(*s, dtype=torch.bfloat16) * 3.2)(B, Hkv, Sk, Dh)),
            "v_cache": _w((lambda *s: torch.randn(*s, dtype=torch.bfloat16) * 0.05)(B, Hkv, Sk, Dh)),
            "wq": _w((lambda *s: torch.randn(*s, dtype=torch.bfloat16) * 3.2)(D, Hq * Dh) * (D ** -0.5)),
            "wo": _w((lambda *s: torch.randn(*s, dtype=torch.bfloat16) * 0.05)(Hq * Dh, D) * ((Hq * Dh) ** -0.5)),
        }
    _A_in = _A_setup()

    def _B_setup():
        B, Sq, D = 1, 1, 448
        Hq, Hkv, Sk, Dh = 16, 8, 8192, 256
        assert Hq % Hkv == 0, (Hq, Hkv)
        return {
            "x": _w((lambda *s: torch.randn(*s, dtype=torch.bfloat16) * 0.05)(B, Sq, D)),
            "k_cache": _w((lambda *s: torch.randn(*s, dtype=torch.bfloat16) * 3.2)(B, Hkv, Sk, Dh)),
            "v_cache": _w((lambda *s: torch.randn(*s, dtype=torch.bfloat16) * 0.05)(B, Hkv, Sk, Dh)),
            "wq": _w((lambda *s: torch.randn(*s, dtype=torch.bfloat16) * 3.2)(D, Hq * Dh) * (D ** -0.5)),
            "wo": _w((lambda *s: torch.randn(*s, dtype=torch.bfloat16) * 0.05)(Hq * Dh, D) * ((Hq * Dh) ** -0.5)),
        }
    _B_in = _B_setup()

    return {
        "A_x": _A_in["x"],
        "A_k_cache": _A_in["k_cache"],
        "A_v_cache": _A_in["v_cache"],
        "A_wq": _A_in["wq"],
        "A_wo": _A_in["wo"],
        "B_x": _B_in["x"],
        "B_k_cache": _B_in["k_cache"],
        "B_v_cache": _B_in["v_cache"],
        "B_wq": _B_in["wq"],
        "B_wo": _B_in["wo"],
        "gate_w": _w((lambda *s: torch.randn(*s, dtype=torch.bfloat16) * 0.1)(448) * 16.0),
    }

def reference(A_x, A_k_cache, A_v_cache, A_wq, A_wo, B_x, B_k_cache, B_v_cache, B_wq, B_wo, gate_w):
    def _A_ref(x, k_cache, v_cache, wq, wo):
        B, Sq, D = x.shape
        Hq, Dh = 16, 256
        Hkv, Sk = k_cache.shape[1], k_cache.shape[2]
        W = min(4096, max(256, Sk // 4))
        rep = Hq // Hkv
        q = (lambda x, *d: x.permute(*d))((x @ wq).reshape(B, Sq, Hq, Dh), 0, 2, 1, 3)
        k = (lambda x, n, axis: torch.repeat_interleave(x, n, dim=axis))(k_cache[:, :, Sk - W:, :], rep, axis=1)
        v = (lambda x, n, axis: torch.repeat_interleave(x, n, dim=axis))(v_cache[:, :, Sk - W:, :], rep, axis=1)
        scores = torch.einsum("bhqd,bhkd->bhqk", q, k) * (Dh ** -0.5)
        p = _softmax(scores, axis=-1)
        o = torch.einsum("bhqk,bhkd->bhqd", p, v)
        return (lambda x, *d: x.permute(*d))(o, 0, 2, 1, 3).reshape(B, Sq, Hq * Dh) @ wo

    def _B_ref(x, k_cache, v_cache, wq, wo):
        B, Sq, D = x.shape
        Hq, Dh = 16, 256
        Hkv = k_cache.shape[1]
        rep = Hq // Hkv
        q = (lambda x, *d: x.permute(*d))((x @ wq).reshape(B, Sq, Hq, Dh), 0, 2, 1, 3)
        k = (lambda x, n, axis: torch.repeat_interleave(x, n, dim=axis))(k_cache, rep, axis=1)
        v = (lambda x, n, axis: torch.repeat_interleave(x, n, dim=axis))(v_cache, rep, axis=1)
        scores = torch.einsum("bhqd,bhkd->bhqk", q, k) * (Dh ** -0.5)
        p = _softmax(scores, axis=-1)
        o = torch.einsum("bhqk,bhkd->bhqd", p, v)
        return (lambda x, *d: x.permute(*d))(o, 0, 2, 1, 3).reshape(B, Sq, Hq * Dh) @ wo

    x = A_x
    g = _sigmoid((x * gate_w).sum(-1, keepdims=True))
    a = _A_ref(x, A_k_cache, A_v_cache, A_wq, A_wo)
    b = _B_ref(x, B_k_cache, B_v_cache, B_wq, B_wo)
    return g * a + (1 - g) * b
```

```asm
; @launch grid=(256,1,1) block=(704,1,1) lds=40960
.amdgcn_target "amdgcn-amd-amdhsa--gfx950"
.text
.globl gated_mix__sliding_block_cached__gqa_block_cached__decode_kernel
.p2align 8
.type gated_mix__sliding_block_cached__gqa_block_cached__decode_kernel,@function
gated_mix__sliding_block_cached__gqa_block_cached__decode_kernel:
    s_cmp_ge_u32 s2, 256
    s_cbranch_scc1 .Lexit
    s_load_dwordx16 s[4:19], s[0:1], 0
    s_load_dwordx8 s[20:27], s[0:1], 64
    s_load_dwordx4 s[28:31], s[0:1], 96
    v_lshrrev_b32 v3, 6, v0
    v_and_b32 v1, 63, v0
    v_readfirstlane_b32 s68, v3
    v_lshlrev_b32 v2, 4, v1
    s_lshr_b32 s69, s2, 5
    s_and_b32 s70, s2, 31
    s_lshr_b32 s71, s2, 7
    s_and_b32 s72, s2, 127
    s_cmp_eq_u32 s70, 25
    s_cselect_b32 s73, 1, 0
    s_mov_b32 s34, 0x10000000
    s_mov_b32 s35, 0x20000
    s_mov_b32 s58, 256
    s_mov_b32 s59, 0x20000
    s_waitcnt lgkmcnt(0)
    s_mov_b32 s32, s30
    s_mov_b32 s33, s31
    s_mov_b32 s56, s28
    s_mov_b32 s57, s29
    s_add_u32 s74, s69, 8
    s_sub_u32 s76, s70, 25
    s_cmp_le_u32 s70, 25
    s_cselect_b32 s74, s74, s69
    s_cselect_b32 s75, s70, s76
    s_lshl_b32 s76, s74, 5
    s_add_u32 s76, s76, s75
    s_mul_i32 s76, s76, 2560
    s_add_u32 s76, s76, 65536
    s_lshl_b32 s77, s69, 5
    s_mul_i32 s77, s77, 2560
    s_add_u32 s77, s77, 65536
    s_cmp_eq_u32 s68, 0
    s_cbranch_scc1 .Lhelper
.Lcompute:
    s_sub_u32 s78, s68, 1
    s_mul_i32 s79, s70, 10
    s_add_u32 s79, s79, s78
    s_lshl_b32 s80, s79, 5
    s_sub_u32 s81, s80, 2048
    s_cmpk_lt_u32 s79, 256
    s_cselect_b32 s80, s80, s81
    s_cselect_b64 s[36:37], s[16:17], s[6:7]
    s_cselect_b64 s[40:41], s[18:19], s[8:9]
    s_cselect_b32 s82, 0, 1
    s_mov_b32 s38, 0x2000000
    s_mov_b32 s39, 0x20000
    s_mov_b32 s42, 0x2000000
    s_mov_b32 s43, 0x20000
    s_lshl_b32 s83, s69, 13
    s_add_u32 s83, s83, s80
    s_lshl_b32 s83, s83, 9
    s_and_b32 s84, s73, s82
    v_mov_b32 v7, 0
    s_barrier
    s_add_u32 s85, s83, 0
    buffer_load_dwordx4 v[8:11], v2, s[36:39], s85 offen offset:0 nt
    buffer_load_dwordx4 v[12:15], v2, s[36:39], s85 offen offset:1024 nt
    buffer_load_dwordx4 v[16:19], v2, s[36:39], s85 offen offset:2048 nt
    buffer_load_dwordx4 v[20:23], v2, s[36:39], s85 offen offset:3072 nt
    s_add_u32 s85, s83, 4096
    buffer_load_dwordx4 v[24:27], v2, s[36:39], s85 offen offset:0 nt
    buffer_load_dwordx4 v[28:31], v2, s[36:39], s85 offen offset:1024 nt
    buffer_load_dwordx4 v[32:35], v2, s[36:39], s85 offen offset:2048 nt
    buffer_load_dwordx4 v[36:39], v2, s[36:39], s85 offen offset:3072 nt
    s_add_u32 s85, s83, 8192
    buffer_load_dwordx4 v[40:43], v2, s[36:39], s85 offen offset:0 nt
    buffer_load_dwordx4 v[44:47], v2, s[36:39], s85 offen offset:1024 nt
    buffer_load_dwordx4 v[48:51], v2, s[36:39], s85 offen offset:2048 nt
    buffer_load_dwordx4 v[52:55], v2, s[36:39], s85 offen offset:3072 nt
    s_add_u32 s85, s83, 12288
    buffer_load_dwordx4 v[56:59], v2, s[36:39], s85 offen offset:0 nt
    buffer_load_dwordx4 v[60:63], v2, s[36:39], s85 offen offset:1024 nt
    buffer_load_dwordx4 v[64:67], v2, s[36:39], s85 offen offset:2048 nt
    buffer_load_dwordx4 v[68:71], v2, s[36:39], s85 offen offset:3072 nt
    s_add_u32 s85, s83, 0
    buffer_load_dwordx4 v[72:75], v2, s[40:43], s85 offen offset:0 nt
    buffer_load_dwordx4 v[76:79], v2, s[40:43], s85 offen offset:1024 nt
    buffer_load_dwordx4 v[80:83], v2, s[40:43], s85 offen offset:2048 nt
    buffer_load_dwordx4 v[84:87], v2, s[40:43], s85 offen offset:3072 nt
    s_add_u32 s85, s83, 4096
    buffer_load_dwordx4 v[88:91], v2, s[40:43], s85 offen offset:0 nt
    buffer_load_dwordx4 v[92:95], v2, s[40:43], s85 offen offset:1024 nt
    buffer_load_dwordx4 v[96:99], v2, s[40:43], s85 offen offset:2048 nt
    buffer_load_dwordx4 v[100:103], v2, s[40:43], s85 offen offset:3072 nt
    s_add_u32 s85, s83, 8192
    buffer_load_dwordx4 v[104:107], v2, s[40:43], s85 offen offset:0 nt
    buffer_load_dwordx4 v[108:111], v2, s[40:43], s85 offen offset:1024 nt
    buffer_load_dwordx4 v[112:115], v2, s[40:43], s85 offen offset:2048 nt
    buffer_load_dwordx4 v[116:119], v2, s[40:43], s85 offen offset:3072 nt
    s_add_u32 s85, s83, 12288
    buffer_load_dwordx4 v[120:123], v2, s[40:43], s85 offen offset:0 nt
    buffer_load_dwordx4 v[124:127], v2, s[40:43], s85 offen offset:1024 nt
    buffer_load_dwordx4 v[128:131], v2, s[40:43], s85 offen offset:2048 nt
    buffer_load_dwordx4 v[132:135], v2, s[40:43], s85 offen offset:3072 nt
    v_and_b32 v3, 2, v1
    v_cmp_ne_u32 s[86:87], 0, v3
    v_and_b32 v3, 1, v1
    v_cmp_ne_u32 s[88:89], 0, v3
    v_mov_b32 v3, 2304
    s_mov_b32 s90, 0
.Lc_waitq:
    ds_read_b32 v4, v3
    s_waitcnt lgkmcnt(0)
    v_readfirstlane_b32 s91, v4
    s_cmp_eq_u32 s91, 1
    s_cbranch_scc1 .Lc_gotq
    s_sleep 2
    s_add_u32 s90, s90, 1
    s_cmp_lt_u32 s90, 16777216
    s_cbranch_scc1 .Lc_waitq
.Lc_gotq:
    v_and_b32 v3, 31, v1
    v_lshlrev_b32 v3, 4, v3
    s_lshl_b32 s91, s84, 10
    v_add_u32 v3, s91, v3
    ds_read_b128 v[136:139], v3 offset:0
    ds_read_b128 v[140:143], v3 offset:512
    s_mov_b32 s92, 0x3db8aa3b
    s_waitcnt lgkmcnt(0)
    s_waitcnt vmcnt(24)
    v_dot2_f32_bf16 v144, v8, v136, 0
    v_dot2_f32_bf16 v145, v8, v140, 0
    v_dot2_f32_bf16 v146, v12, v136, 0
    v_dot2_f32_bf16 v147, v12, v140, 0
    v_dot2c_f32_bf16 v144, v9, v137
    v_dot2c_f32_bf16 v145, v9, v141
    v_dot2c_f32_bf16 v146, v13, v137
    v_dot2c_f32_bf16 v147, v13, v141
    v_dot2c_f32_bf16 v144, v10, v138
    v_dot2c_f32_bf16 v145, v10, v142
    v_dot2c_f32_bf16 v146, v14, v138
    v_dot2c_f32_bf16 v147, v14, v142
    v_dot2c_f32_bf16 v144, v11, v139
    v_dot2c_f32_bf16 v145, v11, v143
    v_dot2c_f32_bf16 v146, v15, v139
    v_dot2c_f32_bf16 v147, v15, v143
    v_dot2_f32_bf16 v148, v16, v136, 0
    v_dot2_f32_bf16 v149, v16, v140, 0
    v_dot2_f32_bf16 v150, v20, v136, 0
    v_dot2_f32_bf16 v151, v20, v140, 0
    v_dot2c_f32_bf16 v148, v17, v137
    v_dot2c_f32_bf16 v149, v17, v141
    v_dot2c_f32_bf16 v150, v21, v137
    v_dot2c_f32_bf16 v151, v21, v141
    v_dot2c_f32_bf16 v148, v18, v138
    v_dot2c_f32_bf16 v149, v18, v142
    v_dot2c_f32_bf16 v150, v22, v138
    v_dot2c_f32_bf16 v151, v22, v142
    v_dot2c_f32_bf16 v148, v19, v139
    v_dot2c_f32_bf16 v149, v19, v143
    v_dot2c_f32_bf16 v150, v23, v139
    v_dot2c_f32_bf16 v151, v23, v143
    v_dot2_f32_bf16 v152, v24, v136, 0
    v_dot2_f32_bf16 v153, v24, v140, 0
    v_dot2_f32_bf16 v154, v28, v136, 0
    v_dot2_f32_bf16 v155, v28, v140, 0
    v_dot2c_f32_bf16 v152, v25, v137
    v_dot2c_f32_bf16 v153, v25, v141
    v_dot2c_f32_bf16 v154, v29, v137
    v_dot2c_f32_bf16 v155, v29, v141
    v_dot2c_f32_bf16 v152, v26, v138
    v_dot2c_f32_bf16 v153, v26, v142
    v_dot2c_f32_bf16 v154, v30, v138
    v_dot2c_f32_bf16 v155, v30, v142
    v_dot2c_f32_bf16 v152, v27, v139
    v_dot2c_f32_bf16 v153, v27, v143
    v_dot2c_f32_bf16 v154, v31, v139
    v_dot2c_f32_bf16 v155, v31, v143
    v_dot2_f32_bf16 v156, v32, v136, 0
    v_dot2_f32_bf16 v157, v32, v140, 0
    v_dot2_f32_bf16 v158, v36, v136, 0
    v_dot2_f32_bf16 v159, v36, v140, 0
    v_dot2c_f32_bf16 v156, v33, v137
    v_dot2c_f32_bf16 v157, v33, v141
    v_dot2c_f32_bf16 v158, v37, v137
    v_dot2c_f32_bf16 v159, v37, v141
    v_dot2c_f32_bf16 v156, v34, v138
    v_dot2c_f32_bf16 v157, v34, v142
    v_dot2c_f32_bf16 v158, v38, v138
    v_dot2c_f32_bf16 v159, v38, v142
    v_dot2c_f32_bf16 v156, v35, v139
    v_dot2c_f32_bf16 v157, v35, v143
    v_dot2c_f32_bf16 v158, v39, v139
    v_dot2c_f32_bf16 v159, v39, v143
    s_nop 3
    v_add_f32_dpp v144, v144, v144 row_ror:8 row_mask:0xf bank_mask:0x3
    v_add_f32_dpp v145, v145, v145 row_ror:8 row_mask:0xf bank_mask:0x3
    v_add_f32_dpp v146, v146, v146 row_ror:8 row_mask:0xf bank_mask:0x3
    v_add_f32_dpp v147, v147, v147 row_ror:8 row_mask:0xf bank_mask:0x3
    v_add_f32_dpp v148, v148, v148 row_ror:8 row_mask:0xf bank_mask:0x3
    v_add_f32_dpp v149, v149, v149 row_ror:8 row_mask:0xf bank_mask:0x3
    v_add_f32_dpp v150, v150, v150 row_ror:8 row_mask:0xf bank_mask:0x3
    v_add_f32_dpp v151, v151, v151 row_ror:8 row_mask:0xf bank_mask:0x3
    v_add_f32_dpp v144, v152, v152 row_ror:8 row_mask:0xf bank_mask:0xc
    v_add_f32_dpp v145, v153, v153 row_ror:8 row_mask:0xf bank_mask:0xc
    v_add_f32_dpp v146, v154, v154 row_ror:8 row_mask:0xf bank_mask:0xc
    v_add_f32_dpp v147, v155, v155 row_ror:8 row_mask:0xf bank_mask:0xc
    v_add_f32_dpp v148, v156, v156 row_ror:8 row_mask:0xf bank_mask:0xc
    v_add_f32_dpp v149, v157, v157 row_ror:8 row_mask:0xf bank_mask:0xc
    v_add_f32_dpp v150, v158, v158 row_ror:8 row_mask:0xf bank_mask:0xc
    v_add_f32_dpp v151, v159, v159 row_ror:8 row_mask:0xf bank_mask:0xc
    v_add_f32_dpp v144, v144, v144 row_shl:4 row_mask:0xf bank_mask:0x5
    v_add_f32_dpp v145, v145, v145 row_shl:4 row_mask:0xf bank_mask:0x5
    v_add_f32_dpp v146, v146, v146 row_shl:4 row_mask:0xf bank_mask:0x5
    v_add_f32_dpp v147, v147, v147 row_shl:4 row_mask:0xf bank_mask:0x5
    v_add_f32_dpp v144, v148, v148 row_shr:4 row_mask:0xf bank_mask:0xa
    v_add_f32_dpp v145, v149, v149 row_shr:4 row_mask:0xf bank_mask:0xa
    v_add_f32_dpp v146, v150, v150 row_shr:4 row_mask:0xf bank_mask:0xa
    v_add_f32_dpp v147, v151, v151 row_shr:4 row_mask:0xf bank_mask:0xa
    v_add_f32_dpp v152, v144, v144 quad_perm:[2,3,0,1] row_mask:0xf bank_mask:0xf
    v_add_f32_dpp v153, v146, v146 quad_perm:[2,3,0,1] row_mask:0xf bank_mask:0xf
    v_add_f32_dpp v154, v145, v145 quad_perm:[2,3,0,1] row_mask:0xf bank_mask:0xf
    v_add_f32_dpp v155, v147, v147 quad_perm:[2,3,0,1] row_mask:0xf bank_mask:0xf
    v_cndmask_b32 v144, v152, v153, s[86:87]
    v_cndmask_b32 v145, v154, v155, s[86:87]
    s_nop 1
    v_add_f32_dpp v152, v144, v144 quad_perm:[1,0,3,2] row_mask:0xf bank_mask:0xf
    v_add_f32_dpp v153, v145, v145 quad_perm:[1,0,3,2] row_mask:0xf bank_mask:0xf
    v_cndmask_b32 v144, v152, v153, s[88:89]
    v_mov_b32 v152, v144
    s_nop 1
    v_permlane16_swap_b32 v144, v152
    v_add_f32 v144, v144, v152
    v_mov_b32 v160, v144
    s_waitcnt vmcnt(16)
    v_dot2_f32_bf16 v144, v40, v136, 0
    v_dot2_f32_bf16 v145, v40, v140, 0
    v_dot2_f32_bf16 v146, v44, v136, 0
    v_dot2_f32_bf16 v147, v44, v140, 0
    v_dot2c_f32_bf16 v144, v41, v137
    v_dot2c_f32_bf16 v145, v41, v141
    v_dot2c_f32_bf16 v146, v45, v137
    v_dot2c_f32_bf16 v147, v45, v141
    v_dot2c_f32_bf16 v144, v42, v138
    v_dot2c_f32_bf16 v145, v42, v142
    v_dot2c_f32_bf16 v146, v46, v138
    v_dot2c_f32_bf16 v147, v46, v142
    v_dot2c_f32_bf16 v144, v43, v139
    v_dot2c_f32_bf16 v145, v43, v143
    v_dot2c_f32_bf16 v146, v47, v139
    v_dot2c_f32_bf16 v147, v47, v143
    v_dot2_f32_bf16 v148, v48, v136, 0
    v_dot2_f32_bf16 v149, v48, v140, 0
    v_dot2_f32_bf16 v150, v52, v136, 0
    v_dot2_f32_bf16 v151, v52, v140, 0
    v_dot2c_f32_bf16 v148, v49, v137
    v_dot2c_f32_bf16 v149, v49, v141
    v_dot2c_f32_bf16 v150, v53, v137
    v_dot2c_f32_bf16 v151, v53, v141
    v_dot2c_f32_bf16 v148, v50, v138
    v_dot2c_f32_bf16 v149, v50, v142
    v_dot2c_f32_bf16 v150, v54, v138
    v_dot2c_f32_bf16 v151, v54, v142
    v_dot2c_f32_bf16 v148, v51, v139
    v_dot2c_f32_bf16 v149, v51, v143
    v_dot2c_f32_bf16 v150, v55, v139
    v_dot2c_f32_bf16 v151, v55, v143
    v_dot2_f32_bf16 v152, v56, v136, 0
    v_dot2_f32_bf16 v153, v56, v140, 0
    v_dot2_f32_bf16 v154, v60, v136, 0
    v_dot2_f32_bf16 v155, v60, v140, 0
    v_dot2c_f32_bf16 v152, v57, v137
    v_dot2c_f32_bf16 v153, v57, v141
    v_dot2c_f32_bf16 v154, v61, v137
    v_dot2c_f32_bf16 v155, v61, v141
    v_dot2c_f32_bf16 v152, v58, v138
    v_dot2c_f32_bf16 v153, v58, v142
    v_dot2c_f32_bf16 v154, v62, v138
    v_dot2c_f32_bf16 v155, v62, v142
    v_dot2c_f32_bf16 v152, v59, v139
    v_dot2c_f32_bf16 v153, v59, v143
    v_dot2c_f32_bf16 v154, v63, v139
    v_dot2c_f32_bf16 v155, v63, v143
    v_dot2_f32_bf16 v156, v64, v136, 0
    v_dot2_f32_bf16 v157, v64, v140, 0
    v_dot2_f32_bf16 v158, v68, v136, 0
    v_dot2_f32_bf16 v159, v68, v140, 0
    v_dot2c_f32_bf16 v156, v65, v137
    v_dot2c_f32_bf16 v157, v65, v141
    v_dot2c_f32_bf16 v158, v69, v137
    v_dot2c_f32_bf16 v159, v69, v141
    v_dot2c_f32_bf16 v156, v66, v138
    v_dot2c_f32_bf16 v157, v66, v142
    v_dot2c_f32_bf16 v158, v70, v138
    v_dot2c_f32_bf16 v159, v70, v142
    v_dot2c_f32_bf16 v156, v67, v139
    v_dot2c_f32_bf16 v157, v67, v143
    v_dot2c_f32_bf16 v158, v71, v139
    v_dot2c_f32_bf16 v159, v71, v143
    s_nop 3
    v_add_f32_dpp v144, v144, v144 row_ror:8 row_mask:0xf bank_mask:0x3
    v_add_f32_dpp v145, v145, v145 row_ror:8 row_mask:0xf bank_mask:0x3
    v_add_f32_dpp v146, v146, v146 row_ror:8 row_mask:0xf bank_mask:0x3
    v_add_f32_dpp v147, v147, v147 row_ror:8 row_mask:0xf bank_mask:0x3
    v_add_f32_dpp v148, v148, v148 row_ror:8 row_mask:0xf bank_mask:0x3
    v_add_f32_dpp v149, v149, v149 row_ror:8 row_mask:0xf bank_mask:0x3
    v_add_f32_dpp v150, v150, v150 row_ror:8 row_mask:0xf bank_mask:0x3
    v_add_f32_dpp v151, v151, v151 row_ror:8 row_mask:0xf bank_mask:0x3
    v_add_f32_dpp v144, v152, v152 row_ror:8 row_mask:0xf bank_mask:0xc
    v_add_f32_dpp v145, v153, v153 row_ror:8 row_mask:0xf bank_mask:0xc
    v_add_f32_dpp v146, v154, v154 row_ror:8 row_mask:0xf bank_mask:0xc
    v_add_f32_dpp v147, v155, v155 row_ror:8 row_mask:0xf bank_mask:0xc
    v_add_f32_dpp v148, v156, v156 row_ror:8 row_mask:0xf bank_mask:0xc
    v_add_f32_dpp v149, v157, v157 row_ror:8 row_mask:0xf bank_mask:0xc
    v_add_f32_dpp v150, v158, v158 row_ror:8 row_mask:0xf bank_mask:0xc
    v_add_f32_dpp v151, v159, v159 row_ror:8 row_mask:0xf bank_mask:0xc
    v_add_f32_dpp v144, v144, v144 row_shl:4 row_mask:0xf bank_mask:0x5
    v_add_f32_dpp v145, v145, v145 row_shl:4 row_mask:0xf bank_mask:0x5
    v_add_f32_dpp v146, v146, v146 row_shl:4 row_mask:0xf bank_mask:0x5
    v_add_f32_dpp v147, v147, v147 row_shl:4 row_mask:0xf bank_mask:0x5
    v_add_f32_dpp v144, v148, v148 row_shr:4 row_mask:0xf bank_mask:0xa
    v_add_f32_dpp v145, v149, v149 row_shr:4 row_mask:0xf bank_mask:0xa
    v_add_f32_dpp v146, v150, v150 row_shr:4 row_mask:0xf bank_mask:0xa
    v_add_f32_dpp v147, v151, v151 row_shr:4 row_mask:0xf bank_mask:0xa
    v_add_f32_dpp v152, v144, v144 quad_perm:[2,3,0,1] row_mask:0xf bank_mask:0xf
    v_add_f32_dpp v153, v146, v146 quad_perm:[2,3,0,1] row_mask:0xf bank_mask:0xf
    v_add_f32_dpp v154, v145, v145 quad_perm:[2,3,0,1] row_mask:0xf bank_mask:0xf
    v_add_f32_dpp v155, v147, v147 quad_perm:[2,3,0,1] row_mask:0xf bank_mask:0xf
    v_cndmask_b32 v144, v152, v153, s[86:87]
    v_cndmask_b32 v145, v154, v155, s[86:87]
    s_nop 1
    v_add_f32_dpp v152, v144, v144 quad_perm:[1,0,3,2] row_mask:0xf bank_mask:0xf
    v_add_f32_dpp v153, v145, v145 quad_perm:[1,0,3,2] row_mask:0xf bank_mask:0xf
    v_cndmask_b32 v144, v152, v153, s[88:89]
    v_mov_b32 v152, v144
    s_nop 1
    v_permlane16_swap_b32 v144, v152
    v_add_f32 v144, v144, v152
    v_mov_b32 v161, v144
    s_cmp_eq_u32 s71, 0
    s_cselect_b64 s[44:45], s[12:13], s[22:23]
    s_mov_b32 s46, 3670016
    s_mov_b32 s47, 0x20000
    s_lshl_b32 s93, s72, 5
    s_and_b32 s94, s78, 7
    s_lshl_b32 s94, s94, 2
    s_add_u32 s93, s93, s94
    s_mul_i32 s93, s93, 896
    v_cmp_gt_u32 vcc, 56, v1
    v_mov_b32 v5, 0x7f000000
    s_nop 0
    v_cndmask_b32 v5, v5, v2, vcc
    buffer_load_dwordx4 v[8:11], v5, s[44:47], s93 offen offset:0 nt
    buffer_load_dwordx4 v[12:15], v5, s[44:47], s93 offen offset:896 nt
    buffer_load_dwordx4 v[16:19], v5, s[44:47], s93 offen offset:1792 nt
    buffer_load_dwordx4 v[20:23], v5, s[44:47], s93 offen offset:2688 nt
    v_max_f32 v144, v160, v161
    s_nop 1
    v_max_f32_dpp v145, v144, v144 quad_perm:[2,3,0,1] row_mask:0xf bank_mask:0xf
    s_nop 1
    v_max_f32_dpp v146, v145, v145 row_shl:4 row_mask:0xf bank_mask:0x5
    v_max_f32_dpp v146, v145, v145 row_shr:4 row_mask:0xf bank_mask:0xa
    s_nop 1
    v_max_f32_dpp v147, v146, v146 row_ror:8 row_mask:0xf bank_mask:0xf
    v_mov_b32 v148, v147
    s_nop 1
    v_permlane32_swap_b32 v147, v148
    v_max_f32 v144, v147, v148
    v_mul_f32 v149, s92, v144
    v_sub_f32 v149, 0, v149
    v_fma_f32 v150, v160, s92, v149
    v_fma_f32 v151, v161, s92, v149
    v_exp_f32 v150, v150
    v_exp_f32 v151, v151
    s_nop 0
    v_add_f32 v152, v150, v151
    v_cvt_pk_bf16_f32 v162, v150, 0
    v_cvt_pk_bf16_f32 v163, 0, v150
    v_cvt_pk_bf16_f32 v164, v151, 0
    v_cvt_pk_bf16_f32 v165, 0, v151
    s_nop 1
    v_add_f32_dpp v145, v152, v152 quad_perm:[2,3,0,1] row_mask:0xf bank_mask:0xf
    s_nop 1
    v_add_f32_dpp v146, v145, v145 row_shl:4 row_mask:0xf bank_mask:0x5
    v_add_f32_dpp v146, v145, v145 row_shr:4 row_mask:0xf bank_mask:0xa
    s_nop 1
    v_add_f32_dpp v147, v146, v146 row_ror:8 row_mask:0xf bank_mask:0xf
    v_mov_b32 v148, v147
    s_nop 1
    v_permlane32_swap_b32 v147, v148
    v_add_f32 v152, v147, v148
    v_sub_f32 v166, 0, v149
    v_mov_b32 v167, v152
    v_mov_b32 v144, 0
    v_mov_b32 v145, 0
    v_mov_b32 v146, 0
    v_mov_b32 v147, 0
    v_mov_b32 v148, 0
    v_mov_b32 v149, 0
    v_mov_b32 v150, 0
    v_mov_b32 v151, 0
    v_mov_b32 v152, 0
    v_mov_b32 v153, 0
    v_mov_b32 v154, 0
    v_mov_b32 v155, 0
    v_mov_b32 v156, 0
    v_mov_b32 v157, 0
    v_mov_b32 v158, 0
    v_mov_b32 v159, 0
    s_waitcnt vmcnt(19)
    v_dot2c_f32_bf16_dpp v144, v162, v72 row_newbcast:0 row_mask:0xf bank_mask:0xf
    v_dot2c_f32_bf16_dpp v145, v163, v72 row_newbcast:0 row_mask:0xf bank_mask:0xf
    v_dot2c_f32_bf16_dpp v146, v162, v73 row_newbcast:0 row_mask:0xf bank_mask:0xf
    v_dot2c_f32_bf16_dpp v147, v163, v73 row_newbcast:0 row_mask:0xf bank_mask:0xf
    v_dot2c_f32_bf16_dpp v148, v162, v74 row_newbcast:0 row_mask:0xf bank_mask:0xf
    v_dot2c_f32_bf16_dpp v149, v163, v74 row_newbcast:0 row_mask:0xf bank_mask:0xf
    v_dot2c_f32_bf16_dpp v150, v162, v75 row_newbcast:0 row_mask:0xf bank_mask:0xf
    v_dot2c_f32_bf16_dpp v151, v163, v75 row_newbcast:0 row_mask:0xf bank_mask:0xf
    v_dot2c_f32_bf16_dpp v152, v162, v72 row_newbcast:1 row_mask:0xf bank_mask:0xf
    v_dot2c_f32_bf16_dpp v153, v163, v72 row_newbcast:1 row_mask:0xf bank_mask:0xf
    v_dot2c_f32_bf16_dpp v154, v162, v73 row_newbcast:1 row_mask:0xf bank_mask:0xf
    v_dot2c_f32_bf16_dpp v155, v163, v73 row_newbcast:1 row_mask:0xf bank_mask:0xf
    v_dot2c_f32_bf16_dpp v156, v162, v74 row_newbcast:1 row_mask:0xf bank_mask:0xf
    v_dot2c_f32_bf16_dpp v157, v163, v74 row_newbcast:1 row_mask:0xf bank_mask:0xf
    v_dot2c_f32_bf16_dpp v158, v162, v75 row_newbcast:1 row_mask:0xf bank_mask:0xf
    v_dot2c_f32_bf16_dpp v159, v163, v75 row_newbcast:1 row_mask:0xf bank_mask:0xf
    s_waitcnt vmcnt(18)
    v_dot2c_f32_bf16_dpp v144, v162, v76 row_newbcast:2 row_mask:0xf bank_mask:0xf
    v_dot2c_f32_bf16_dpp v145, v163, v76 row_newbcast:2 row_mask:0xf bank_mask:0xf
    v_dot2c_f32_bf16_dpp v146, v162, v77 row_newbcast:2 row_mask:0xf bank_mask:0xf
    v_dot2c_f32_bf16_dpp v147, v163, v77 row_newbcast:2 row_mask:0xf bank_mask:0xf
    v_dot2c_f32_bf16_dpp v148, v162, v78 row_newbcast:2 row_mask:0xf bank_mask:0xf
    v_dot2c_f32_bf16_dpp v149, v163, v78 row_newbcast:2 row_mask:0xf bank_mask:0xf
    v_dot2c_f32_bf16_dpp v150, v162, v79 row_newbcast:2 row_mask:0xf bank_mask:0xf
    v_dot2c_f32_bf16_dpp v151, v163, v79 row_newbcast:2 row_mask:0xf bank_mask:0xf
    v_dot2c_f32_bf16_dpp v152, v162, v76 row_newbcast:3 row_mask:0xf bank_mask:0xf
    v_dot2c_f32_bf16_dpp v153, v163, v76 row_newbcast:3 row_mask:0xf bank_mask:0xf
    v_dot2c_f32_bf16_dpp v154, v162, v77 row_newbcast:3 row_mask:0xf bank_mask:0xf
    v_dot2c_f32_bf16_dpp v155, v163, v77 row_newbcast:3 row_mask:0xf bank_mask:0xf
    v_dot2c_f32_bf16_dpp v156, v162, v78 row_newbcast:3 row_mask:0xf bank_mask:0xf
    v_dot2c_f32_bf16_dpp v157, v163, v78 row_newbcast:3 row_mask:0xf bank_mask:0xf
    v_dot2c_f32_bf16_dpp v158, v162, v79 row_newbcast:3 row_mask:0xf bank_mask:0xf
    v_dot2c_f32_bf16_dpp v159, v163, v79 row_newbcast:3 row_mask:0xf bank_mask:0xf
    s_waitcnt vmcnt(17)
    v_dot2c_f32_bf16_dpp v144, v162, v80 row_newbcast:4 row_mask:0xf bank_mask:0xf
    v_dot2c_f32_bf16_dpp v145, v163, v80 row_newbcast:4 row_mask:0xf bank_mask:0xf
    v_dot2c_f32_bf16_dpp v146, v162, v81 row_newbcast:4 row_mask:0xf bank_mask:0xf
    v_dot2c_f32_bf16_dpp v147, v163, v81 row_newbcast:4 row_mask:0xf bank_mask:0xf
    v_dot2c_f32_bf16_dpp v148, v162, v82 row_newbcast:4 row_mask:0xf bank_mask:0xf
    v_dot2c_f32_bf16_dpp v149, v163, v82 row_newbcast:4 row_mask:0xf bank_mask:0xf
    v_dot2c_f32_bf16_dpp v150, v162, v83 row_newbcast:4 row_mask:0xf bank_mask:0xf
    v_dot2c_f32_bf16_dpp v151, v163, v83 row_newbcast:4 row_mask:0xf bank_mask:0xf
    v_dot2c_f32_bf16_dpp v152, v162, v80 row_newbcast:5 row_mask:0xf bank_mask:0xf
    v_dot2c_f32_bf16_dpp v153, v163, v80 row_newbcast:5 row_mask:0xf bank_mask:0xf
    v_dot2c_f32_bf16_dpp v154, v162, v81 row_newbcast:5 row_mask:0xf bank_mask:0xf
    v_dot2c_f32_bf16_dpp v155, v163, v81 row_newbcast:5 row_mask:0xf bank_mask:0xf
    v_dot2c_f32_bf16_dpp v156, v162, v82 row_newbcast:5 row_mask:0xf bank_mask:0xf
    v_dot2c_f32_bf16_dpp v157, v163, v82 row_newbcast:5 row_mask:0xf bank_mask:0xf
    v_dot2c_f32_bf16_dpp v158, v162, v83 row_newbcast:5 row_mask:0xf bank_mask:0xf
    v_dot2c_f32_bf16_dpp v159, v163, v83 row_newbcast:5 row_mask:0xf bank_mask:0xf
    s_waitcnt vmcnt(16)
    v_dot2c_f32_bf16_dpp v144, v162, v84 row_newbcast:6 row_mask:0xf bank_mask:0xf
    v_dot2c_f32_bf16_dpp v145, v163, v84 row_newbcast:6 row_mask:0xf bank_mask:0xf
    v_dot2c_f32_bf16_dpp v146, v162, v85 row_newbcast:6 row_mask:0xf bank_mask:0xf
    v_dot2c_f32_bf16_dpp v147, v163, v85 row_newbcast:6 row_mask:0xf bank_mask:0xf
    v_dot2c_f32_bf16_dpp v148, v162, v86 row_newbcast:6 row_mask:0xf bank_mask:0xf
    v_dot2c_f32_bf16_dpp v149, v163, v86 row_newbcast:6 row_mask:0xf bank_mask:0xf
    v_dot2c_f32_bf16_dpp v150, v162, v87 row_newbcast:6 row_mask:0xf bank_mask:0xf
    v_dot2c_f32_bf16_dpp v151, v163, v87 row_newbcast:6 row_mask:0xf bank_mask:0xf
    v_dot2c_f32_bf16_dpp v152, v162, v84 row_newbcast:7 row_mask:0xf bank_mask:0xf
    v_dot2c_f32_bf16_dpp v153, v163, v84 row_newbcast:7 row_mask:0xf bank_mask:0xf
    v_dot2c_f32_bf16_dpp v154, v162, v85 row_newbcast:7 row_mask:0xf bank_mask:0xf
    v_dot2c_f32_bf16_dpp v155, v163, v85 row_newbcast:7 row_mask:0xf bank_mask:0xf
    v_dot2c_f32_bf16_dpp v156, v162, v86 row_newbcast:7 row_mask:0xf bank_mask:0xf
    v_dot2c_f32_bf16_dpp v157, v163, v86 row_newbcast:7 row_mask:0xf bank_mask:0xf
    v_dot2c_f32_bf16_dpp v158, v162, v87 row_newbcast:7 row_mask:0xf bank_mask:0xf
    v_dot2c_f32_bf16_dpp v159, v163, v87 row_newbcast:7 row_mask:0xf bank_mask:0xf
    s_waitcnt vmcnt(15)
    v_dot2c_f32_bf16_dpp v144, v162, v88 row_newbcast:8 row_mask:0xf bank_mask:0xf
    v_dot2c_f32_bf16_dpp v145, v163, v88 row_newbcast:8 row_mask:0xf bank_mask:0xf
    v_dot2c_f32_bf16_dpp v146, v162, v89 row_newbcast:8 row_mask:0xf bank_mask:0xf
    v_dot2c_f32_bf16_dpp v147, v163, v89 row_newbcast:8 row_mask:0xf bank_mask:0xf
    v_dot2c_f32_bf16_dpp v148, v162, v90 row_newbcast:8 row_mask:0xf bank_mask:0xf
    v_dot2c_f32_bf16_dpp v149, v163, v90 row_newbcast:8 row_mask:0xf bank_mask:0xf
    v_dot2c_f32_bf16_dpp v150, v162, v91 row_newbcast:8 row_mask:0xf bank_mask:0xf
    v_dot2c_f32_bf16_dpp v151, v163, v91 row_newbcast:8 row_mask:0xf bank_mask:0xf
    v_dot2c_f32_bf16_dpp v152, v162, v88 row_newbcast:9 row_mask:0xf bank_mask:0xf
    v_dot2c_f32_bf16_dpp v153, v163, v88 row_newbcast:9 row_mask:0xf bank_mask:0xf
    v_dot2c_f32_bf16_dpp v154, v162, v89 row_newbcast:9 row_mask:0xf bank_mask:0xf
    v_dot2c_f32_bf16_dpp v155, v163, v89 row_newbcast:9 row_mask:0xf bank_mask:0xf
    v_dot2c_f32_bf16_dpp v156, v162, v90 row_newbcast:9 row_mask:0xf bank_mask:0xf
    v_dot2c_f32_bf16_dpp v157, v163, v90 row_newbcast:9 row_mask:0xf bank_mask:0xf
    v_dot2c_f32_bf16_dpp v158, v162, v91 row_newbcast:9 row_mask:0xf bank_mask:0xf
    v_dot2c_f32_bf16_dpp v159, v163, v91 row_newbcast:9 row_mask:0xf bank_mask:0xf
    s_waitcnt vmcnt(14)
    v_dot2c_f32_bf16_dpp v144, v162, v92 row_newbcast:10 row_mask:0xf bank_mask:0xf
    v_dot2c_f32_bf16_dpp v145, v163, v92 row_newbcast:10 row_mask:0xf bank_mask:0xf
    v_dot2c_f32_bf16_dpp v146, v162, v93 row_newbcast:10 row_mask:0xf bank_mask:0xf
    v_dot2c_f32_bf16_dpp v147, v163, v93 row_newbcast:10 row_mask:0xf bank_mask:0xf
    v_dot2c_f32_bf16_dpp v148, v162, v94 row_newbcast:10 row_mask:0xf bank_mask:0xf
    v_dot2c_f32_bf16_dpp v149, v163, v94 row_newbcast:10 row_mask:0xf bank_mask:0xf
    v_dot2c_f32_bf16_dpp v150, v162, v95 row_newbcast:10 row_mask:0xf bank_mask:0xf
    v_dot2c_f32_bf16_dpp v151, v163, v95 row_newbcast:10 row_mask:0xf bank_mask:0xf
    v_dot2c_f32_bf16_dpp v152, v162, v92 row_newbcast:11 row_mask:0xf bank_mask:0xf
    v_dot2c_f32_bf16_dpp v153, v163, v92 row_newbcast:11 row_mask:0xf bank_mask:0xf
    v_dot2c_f32_bf16_dpp v154, v162, v93 row_newbcast:11 row_mask:0xf bank_mask:0xf
    v_dot2c_f32_bf16_dpp v155, v163, v93 row_newbcast:11 row_mask:0xf bank_mask:0xf
    v_dot2c_f32_bf16_dpp v156, v162, v94 row_newbcast:11 row_mask:0xf bank_mask:0xf
    v_dot2c_f32_bf16_dpp v157, v163, v94 row_newbcast:11 row_mask:0xf bank_mask:0xf
    v_dot2c_f32_bf16_dpp v158, v162, v95 row_newbcast:11 row_mask:0xf bank_mask:0xf
    v_dot2c_f32_bf16_dpp v159, v163, v95 row_newbcast:11 row_mask:0xf bank_mask:0xf
    s_waitcnt vmcnt(13)
    v_dot2c_f32_bf16_dpp v144, v162, v96 row_newbcast:12 row_mask:0xf bank_mask:0xf
    v_dot2c_f32_bf16_dpp v145, v163, v96 row_newbcast:12 row_mask:0xf bank_mask:0xf
    v_dot2c_f32_bf16_dpp v146, v162, v97 row_newbcast:12 row_mask:0xf bank_mask:0xf
    v_dot2c_f32_bf16_dpp v147, v163, v97 row_newbcast:12 row_mask:0xf bank_mask:0xf
    v_dot2c_f32_bf16_dpp v148, v162, v98 row_newbcast:12 row_mask:0xf bank_mask:0xf
    v_dot2c_f32_bf16_dpp v149, v163, v98 row_newbcast:12 row_mask:0xf bank_mask:0xf
    v_dot2c_f32_bf16_dpp v150, v162, v99 row_newbcast:12 row_mask:0xf bank_mask:0xf
    v_dot2c_f32_bf16_dpp v151, v163, v99 row_newbcast:12 row_mask:0xf bank_mask:0xf
    v_dot2c_f32_bf16_dpp v152, v162, v96 row_newbcast:13 row_mask:0xf bank_mask:0xf
    v_dot2c_f32_bf16_dpp v153, v163, v96 row_newbcast:13 row_mask:0xf bank_mask:0xf
    v_dot2c_f32_bf16_dpp v154, v162, v97 row_newbcast:13 row_mask:0xf bank_mask:0xf
    v_dot2c_f32_bf16_dpp v155, v163, v97 row_newbcast:13 row_mask:0xf bank_mask:0xf
    v_dot2c_f32_bf16_dpp v156, v162, v98 row_newbcast:13 row_mask:0xf bank_mask:0xf
    v_dot2c_f32_bf16_dpp v157, v163, v98 row_newbcast:13 row_mask:0xf bank_mask:0xf
    v_dot2c_f32_bf16_dpp v158, v162, v99 row_newbcast:13 row_mask:0xf bank_mask:0xf
    v_dot2c_f32_bf16_dpp v159, v163, v99 row_newbcast:13 row_mask:0xf bank_mask:0xf
    s_waitcnt vmcnt(12)
    v_dot2c_f32_bf16_dpp v144, v162, v100 row_newbcast:14 row_mask:0xf bank_mask:0xf
    v_dot2c_f32_bf16_dpp v145, v163, v100 row_newbcast:14 row_mask:0xf bank_mask:0xf
    v_dot2c_f32_bf16_dpp v146, v162, v101 row_newbcast:14 row_mask:0xf bank_mask:0xf
    v_dot2c_f32_bf16_dpp v147, v163, v101 row_newbcast:14 row_mask:0xf bank_mask:0xf
    v_dot2c_f32_bf16_dpp v148, v162, v102 row_newbcast:14 row_mask:0xf bank_mask:0xf
    v_dot2c_f32_bf16_dpp v149, v163, v102 row_newbcast:14 row_mask:0xf bank_mask:0xf
    v_dot2c_f32_bf16_dpp v150, v162, v103 row_newbcast:14 row_mask:0xf bank_mask:0xf
    v_dot2c_f32_bf16_dpp v151, v163, v103 row_newbcast:14 row_mask:0xf bank_mask:0xf
    v_dot2c_f32_bf16_dpp v152, v162, v100 row_newbcast:15 row_mask:0xf bank_mask:0xf
    v_dot2c_f32_bf16_dpp v153, v163, v100 row_newbcast:15 row_mask:0xf bank_mask:0xf
    v_dot2c_f32_bf16_dpp v154, v162, v101 row_newbcast:15 row_mask:0xf bank_mask:0xf
    v_dot2c_f32_bf16_dpp v155, v163, v101 row_newbcast:15 row_mask:0xf bank_mask:0xf
    v_dot2c_f32_bf16_dpp v156, v162, v102 row_newbcast:15 row_mask:0xf bank_mask:0xf
    v_dot2c_f32_bf16_dpp v157, v163, v102 row_newbcast:15 row_mask:0xf bank_mask:0xf
    v_dot2c_f32_bf16_dpp v158, v162, v103 row_newbcast:15 row_mask:0xf bank_mask:0xf
    v_dot2c_f32_bf16_dpp v159, v163, v103 row_newbcast:15 row_mask:0xf bank_mask:0xf
    s_waitcnt vmcnt(11)
    v_dot2c_f32_bf16_dpp v144, v164, v104 row_newbcast:0 row_mask:0xf bank_mask:0xf
    v_dot2c_f32_bf16_dpp v145, v165, v104 row_newbcast:0 row_mask:0xf bank_mask:0xf
    v_dot2c_f32_bf16_dpp v146, v164, v105 row_newbcast:0 row_mask:0xf bank_mask:0xf
    v_dot2c_f32_bf16_dpp v147, v165, v105 row_newbcast:0 row_mask:0xf bank_mask:0xf
    v_dot2c_f32_bf16_dpp v148, v164, v106 row_newbcast:0 row_mask:0xf bank_mask:0xf
    v_dot2c_f32_bf16_dpp v149, v165, v106 row_newbcast:0 row_mask:0xf bank_mask:0xf
    v_dot2c_f32_bf16_dpp v150, v164, v107 row_newbcast:0 row_mask:0xf bank_mask:0xf
    v_dot2c_f32_bf16_dpp v151, v165, v107 row_newbcast:0 row_mask:0xf bank_mask:0xf
    v_dot2c_f32_bf16_dpp v152, v164, v104 row_newbcast:1 row_mask:0xf bank_mask:0xf
    v_dot2c_f32_bf16_dpp v153, v165, v104 row_newbcast:1 row_mask:0xf bank_mask:0xf
    v_dot2c_f32_bf16_dpp v154, v164, v105 row_newbcast:1 row_mask:0xf bank_mask:0xf
    v_dot2c_f32_bf16_dpp v155, v165, v105 row_newbcast:1 row_mask:0xf bank_mask:0xf
    v_dot2c_f32_bf16_dpp v156, v164, v106 row_newbcast:1 row_mask:0xf bank_mask:0xf
    v_dot2c_f32_bf16_dpp v157, v165, v106 row_newbcast:1 row_mask:0xf bank_mask:0xf
    v_dot2c_f32_bf16_dpp v158, v164, v107 row_newbcast:1 row_mask:0xf bank_mask:0xf
    v_dot2c_f32_bf16_dpp v159, v165, v107 row_newbcast:1 row_mask:0xf bank_mask:0xf
    s_waitcnt vmcnt(10)
    v_dot2c_f32_bf16_dpp v144, v164, v108 row_newbcast:2 row_mask:0xf bank_mask:0xf
    v_dot2c_f32_bf16_dpp v145, v165, v108 row_newbcast:2 row_mask:0xf bank_mask:0xf
    v_dot2c_f32_bf16_dpp v146, v164, v109 row_newbcast:2 row_mask:0xf bank_mask:0xf
    v_dot2c_f32_bf16_dpp v147, v165, v109 row_newbcast:2 row_mask:0xf bank_mask:0xf
    v_dot2c_f32_bf16_dpp v148, v164, v110 row_newbcast:2 row_mask:0xf bank_mask:0xf
    v_dot2c_f32_bf16_dpp v149, v165, v110 row_newbcast:2 row_mask:0xf bank_mask:0xf
    v_dot2c_f32_bf16_dpp v150, v164, v111 row_newbcast:2 row_mask:0xf bank_mask:0xf
    v_dot2c_f32_bf16_dpp v151, v165, v111 row_newbcast:2 row_mask:0xf bank_mask:0xf
    v_dot2c_f32_bf16_dpp v152, v164, v108 row_newbcast:3 row_mask:0xf bank_mask:0xf
    v_dot2c_f32_bf16_dpp v153, v165, v108 row_newbcast:3 row_mask:0xf bank_mask:0xf
    v_dot2c_f32_bf16_dpp v154, v164, v109 row_newbcast:3 row_mask:0xf bank_mask:0xf
    v_dot2c_f32_bf16_dpp v155, v165, v109 row_newbcast:3 row_mask:0xf bank_mask:0xf
    v_dot2c_f32_bf16_dpp v156, v164, v110 row_newbcast:3 row_mask:0xf bank_mask:0xf
    v_dot2c_f32_bf16_dpp v157, v165, v110 row_newbcast:3 row_mask:0xf bank_mask:0xf
    v_dot2c_f32_bf16_dpp v158, v164, v111 row_newbcast:3 row_mask:0xf bank_mask:0xf
    v_dot2c_f32_bf16_dpp v159, v165, v111 row_newbcast:3 row_mask:0xf bank_mask:0xf
    s_waitcnt vmcnt(9)
    v_dot2c_f32_bf16_dpp v144, v164, v112 row_newbcast:4 row_mask:0xf bank_mask:0xf
    v_dot2c_f32_bf16_dpp v145, v165, v112 row_newbcast:4 row_mask:0xf bank_mask:0xf
    v_dot2c_f32_bf16_dpp v146, v164, v113 row_newbcast:4 row_mask:0xf bank_mask:0xf
    v_dot2c_f32_bf16_dpp v147, v165, v113 row_newbcast:4 row_mask:0xf bank_mask:0xf
    v_dot2c_f32_bf16_dpp v148, v164, v114 row_newbcast:4 row_mask:0xf bank_mask:0xf
    v_dot2c_f32_bf16_dpp v149, v165, v114 row_newbcast:4 row_mask:0xf bank_mask:0xf
    v_dot2c_f32_bf16_dpp v150, v164, v115 row_newbcast:4 row_mask:0xf bank_mask:0xf
    v_dot2c_f32_bf16_dpp v151, v165, v115 row_newbcast:4 row_mask:0xf bank_mask:0xf
    v_dot2c_f32_bf16_dpp v152, v164, v112 row_newbcast:5 row_mask:0xf bank_mask:0xf
    v_dot2c_f32_bf16_dpp v153, v165, v112 row_newbcast:5 row_mask:0xf bank_mask:0xf
    v_dot2c_f32_bf16_dpp v154, v164, v113 row_newbcast:5 row_mask:0xf bank_mask:0xf
    v_dot2c_f32_bf16_dpp v155, v165, v113 row_newbcast:5 row_mask:0xf bank_mask:0xf
    v_dot2c_f32_bf16_dpp v156, v164, v114 row_newbcast:5 row_mask:0xf bank_mask:0xf
    v_dot2c_f32_bf16_dpp v157, v165, v114 row_newbcast:5 row_mask:0xf bank_mask:0xf
    v_dot2c_f32_bf16_dpp v158, v164, v115 row_newbcast:5 row_mask:0xf bank_mask:0xf
    v_dot2c_f32_bf16_dpp v159, v165, v115 row_newbcast:5 row_mask:0xf bank_mask:0xf
    s_waitcnt vmcnt(8)
    v_dot2c_f32_bf16_dpp v144, v164, v116 row_newbcast:6 row_mask:0xf bank_mask:0xf
    v_dot2c_f32_bf16_dpp v145, v165, v116 row_newbcast:6 row_mask:0xf bank_mask:0xf
    v_dot2c_f32_bf16_dpp v146, v164, v117 row_newbcast:6 row_mask:0xf bank_mask:0xf
    v_dot2c_f32_bf16_dpp v147, v165, v117 row_newbcast:6 row_mask:0xf bank_mask:0xf
    v_dot2c_f32_bf16_dpp v148, v164, v118 row_newbcast:6 row_mask:0xf bank_mask:0xf
    v_dot2c_f32_bf16_dpp v149, v165, v118 row_newbcast:6 row_mask:0xf bank_mask:0xf
    v_dot2c_f32_bf16_dpp v150, v164, v119 row_newbcast:6 row_mask:0xf bank_mask:0xf
    v_dot2c_f32_bf16_dpp v151, v165, v119 row_newbcast:6 row_mask:0xf bank_mask:0xf
    v_dot2c_f32_bf16_dpp v152, v164, v116 row_newbcast:7 row_mask:0xf bank_mask:0xf
    v_dot2c_f32_bf16_dpp v153, v165, v116 row_newbcast:7 row_mask:0xf bank_mask:0xf
    v_dot2c_f32_bf16_dpp v154, v164, v117 row_newbcast:7 row_mask:0xf bank_mask:0xf
    v_dot2c_f32_bf16_dpp v155, v165, v117 row_newbcast:7 row_mask:0xf bank_mask:0xf
    v_dot2c_f32_bf16_dpp v156, v164, v118 row_newbcast:7 row_mask:0xf bank_mask:0xf
    v_dot2c_f32_bf16_dpp v157, v165, v118 row_newbcast:7 row_mask:0xf bank_mask:0xf
    v_dot2c_f32_bf16_dpp v158, v164, v119 row_newbcast:7 row_mask:0xf bank_mask:0xf
    v_dot2c_f32_bf16_dpp v159, v165, v119 row_newbcast:7 row_mask:0xf bank_mask:0xf
    s_waitcnt vmcnt(7)
    v_dot2c_f32_bf16_dpp v144, v164, v120 row_newbcast:8 row_mask:0xf bank_mask:0xf
    v_dot2c_f32_bf16_dpp v145, v165, v120 row_newbcast:8 row_mask:0xf bank_mask:0xf
    v_dot2c_f32_bf16_dpp v146, v164, v121 row_newbcast:8 row_mask:0xf bank_mask:0xf
    v_dot2c_f32_bf16_dpp v147, v165, v121 row_newbcast:8 row_mask:0xf bank_mask:0xf
    v_dot2c_f32_bf16_dpp v148, v164, v122 row_newbcast:8 row_mask:0xf bank_mask:0xf
    v_dot2c_f32_bf16_dpp v149, v165, v122 row_newbcast:8 row_mask:0xf bank_mask:0xf
    v_dot2c_f32_bf16_dpp v150, v164, v123 row_newbcast:8 row_mask:0xf bank_mask:0xf
    v_dot2c_f32_bf16_dpp v151, v165, v123 row_newbcast:8 row_mask:0xf bank_mask:0xf
    v_dot2c_f32_bf16_dpp v152, v164, v120 row_newbcast:9 row_mask:0xf bank_mask:0xf
    v_dot2c_f32_bf16_dpp v153, v165, v120 row_newbcast:9 row_mask:0xf bank_mask:0xf
    v_dot2c_f32_bf16_dpp v154, v164, v121 row_newbcast:9 row_mask:0xf bank_mask:0xf
    v_dot2c_f32_bf16_dpp v155, v165, v121 row_newbcast:9 row_mask:0xf bank_mask:0xf
    v_dot2c_f32_bf16_dpp v156, v164, v122 row_newbcast:9 row_mask:0xf bank_mask:0xf
    v_dot2c_f32_bf16_dpp v157, v165, v122 row_newbcast:9 row_mask:0xf bank_mask:0xf
    v_dot2c_f32_bf16_dpp v158, v164, v123 row_newbcast:9 row_mask:0xf bank_mask:0xf
    v_dot2c_f32_bf16_dpp v159, v165, v123 row_newbcast:9 row_mask:0xf bank_mask:0xf
    s_waitcnt vmcnt(6)
    v_dot2c_f32_bf16_dpp v144, v164, v124 row_newbcast:10 row_mask:0xf bank_mask:0xf
    v_dot2c_f32_bf16_dpp v145, v165, v124 row_newbcast:10 row_mask:0xf bank_mask:0xf
    v_dot2c_f32_bf16_dpp v146, v164, v125 row_newbcast:10 row_mask:0xf bank_mask:0xf
    v_dot2c_f32_bf16_dpp v147, v165, v125 row_newbcast:10 row_mask:0xf bank_mask:0xf
    v_dot2c_f32_bf16_dpp v148, v164, v126 row_newbcast:10 row_mask:0xf bank_mask:0xf
    v_dot2c_f32_bf16_dpp v149, v165, v126 row_newbcast:10 row_mask:0xf bank_mask:0xf
    v_dot2c_f32_bf16_dpp v150, v164, v127 row_newbcast:10 row_mask:0xf bank_mask:0xf
    v_dot2c_f32_bf16_dpp v151, v165, v127 row_newbcast:10 row_mask:0xf bank_mask:0xf
    v_dot2c_f32_bf16_dpp v152, v164, v124 row_newbcast:11 row_mask:0xf bank_mask:0xf
    v_dot2c_f32_bf16_dpp v153, v165, v124 row_newbcast:11 row_mask:0xf bank_mask:0xf
    v_dot2c_f32_bf16_dpp v154, v164, v125 row_newbcast:11 row_mask:0xf bank_mask:0xf
    v_dot2c_f32_bf16_dpp v155, v165, v125 row_newbcast:11 row_mask:0xf bank_mask:0xf
    v_dot2c_f32_bf16_dpp v156, v164, v126 row_newbcast:11 row_mask:0xf bank_mask:0xf
    v_dot2c_f32_bf16_dpp v157, v165, v126 row_newbcast:11 row_mask:0xf bank_mask:0xf
    v_dot2c_f32_bf16_dpp v158, v164, v127 row_newbcast:11 row_mask:0xf bank_mask:0xf
    v_dot2c_f32_bf16_dpp v159, v165, v127 row_newbcast:11 row_mask:0xf bank_mask:0xf
    s_waitcnt vmcnt(5)
    v_dot2c_f32_bf16_dpp v144, v164, v128 row_newbcast:12 row_mask:0xf bank_mask:0xf
    v_dot2c_f32_bf16_dpp v145, v165, v128 row_newbcast:12 row_mask:0xf bank_mask:0xf
    v_dot2c_f32_bf16_dpp v146, v164, v129 row_newbcast:12 row_mask:0xf bank_mask:0xf
    v_dot2c_f32_bf16_dpp v147, v165, v129 row_newbcast:12 row_mask:0xf bank_mask:0xf
    v_dot2c_f32_bf16_dpp v148, v164, v130 row_newbcast:12 row_mask:0xf bank_mask:0xf
    v_dot2c_f32_bf16_dpp v149, v165, v130 row_newbcast:12 row_mask:0xf bank_mask:0xf
    v_dot2c_f32_bf16_dpp v150, v164, v131 row_newbcast:12 row_mask:0xf bank_mask:0xf
    v_dot2c_f32_bf16_dpp v151, v165, v131 row_newbcast:12 row_mask:0xf bank_mask:0xf
    v_dot2c_f32_bf16_dpp v152, v164, v128 row_newbcast:13 row_mask:0xf bank_mask:0xf
    v_dot2c_f32_bf16_dpp v153, v165, v128 row_newbcast:13 row_mask:0xf bank_mask:0xf
    v_dot2c_f32_bf16_dpp v154, v164, v129 row_newbcast:13 row_mask:0xf bank_mask:0xf
    v_dot2c_f32_bf16_dpp v155, v165, v129 row_newbcast:13 row_mask:0xf bank_mask:0xf
    v_dot2c_f32_bf16_dpp v156, v164, v130 row_newbcast:13 row_mask:0xf bank_mask:0xf
    v_dot2c_f32_bf16_dpp v157, v165, v130 row_newbcast:13 row_mask:0xf bank_mask:0xf
    v_dot2c_f32_bf16_dpp v158, v164, v131 row_newbcast:13 row_mask:0xf bank_mask:0xf
    v_dot2c_f32_bf16_dpp v159, v165, v131 row_newbcast:13 row_mask:0xf bank_mask:0xf
    s_waitcnt vmcnt(4)
    v_dot2c_f32_bf16_dpp v144, v164, v132 row_newbcast:14 row_mask:0xf bank_mask:0xf
    v_dot2c_f32_bf16_dpp v145, v165, v132 row_newbcast:14 row_mask:0xf bank_mask:0xf
    v_dot2c_f32_bf16_dpp v146, v164, v133 row_newbcast:14 row_mask:0xf bank_mask:0xf
    v_dot2c_f32_bf16_dpp v147, v165, v133 row_newbcast:14 row_mask:0xf bank_mask:0xf
    v_dot2c_f32_bf16_dpp v148, v164, v134 row_newbcast:14 row_mask:0xf bank_mask:0xf
    v_dot2c_f32_bf16_dpp v149, v165, v134 row_newbcast:14 row_mask:0xf bank_mask:0xf
    v_dot2c_f32_bf16_dpp v150, v164, v135 row_newbcast:14 row_mask:0xf bank_mask:0xf
    v_dot2c_f32_bf16_dpp v151, v165, v135 row_newbcast:14 row_mask:0xf bank_mask:0xf
    v_dot2c_f32_bf16_dpp v152, v164, v132 row_newbcast:15 row_mask:0xf bank_mask:0xf
    v_dot2c_f32_bf16_dpp v153, v165, v132 row_newbcast:15 row_mask:0xf bank_mask:0xf
    v_dot2c_f32_bf16_dpp v154, v164, v133 row_newbcast:15 row_mask:0xf bank_mask:0xf
    v_dot2c_f32_bf16_dpp v155, v165, v133 row_newbcast:15 row_mask:0xf bank_mask:0xf
    v_dot2c_f32_bf16_dpp v156, v164, v134 row_newbcast:15 row_mask:0xf bank_mask:0xf
    v_dot2c_f32_bf16_dpp v157, v165, v134 row_newbcast:15 row_mask:0xf bank_mask:0xf
    v_dot2c_f32_bf16_dpp v158, v164, v135 row_newbcast:15 row_mask:0xf bank_mask:0xf
    v_dot2c_f32_bf16_dpp v159, v165, v135 row_newbcast:15 row_mask:0xf bank_mask:0xf
    s_nop 3
    v_permlane32_swap_b32 v144, v152
    v_permlane32_swap_b32 v145, v153
    v_permlane32_swap_b32 v146, v154
    v_permlane32_swap_b32 v147, v155
    v_permlane32_swap_b32 v148, v156
    v_permlane32_swap_b32 v149, v157
    v_permlane32_swap_b32 v150, v158
    v_permlane32_swap_b32 v151, v159
    v_add_f32 v144, v144, v152
    v_add_f32 v145, v145, v153
    v_add_f32 v146, v146, v154
    v_add_f32 v147, v147, v155
    v_add_f32 v148, v148, v156
    v_add_f32 v149, v149, v157
    v_add_f32 v150, v150, v158
    v_add_f32 v151, v151, v159
    s_lshl_b32 s91, s78, 11
    v_lshlrev_b32 v3, 5, v1
    v_add_u32 v3, s91, v3
    ds_write_b128 v3, v[144:147] offset:4096
    ds_write_b128 v3, v[148:151] offset:4112
    s_lshl_b32 s91, s78, 4
    v_lshlrev_b32 v4, 3, v1
    v_add_u32 v4, s91, v4
    v_cmp_gt_u32 vcc, 2, v1
    s_and_saveexec_b64 s[94:95], vcc
    ds_write_b64 v4, v[166:167] offset:2048
    s_mov_b64 exec, s[94:95]
    s_waitcnt lgkmcnt(0)
    s_barrier
    s_cmp_ge_u32 s78, 8
    s_cbranch_scc1 .Lc_skip_to_b3
    s_lshr_b32 s91, s78, 2
    s_and_b32 s93, s78, 3
    s_lshl_b32 s94, s91, 10
    s_lshl_b32 s95, s93, 8
    s_add_u32 s94, s94, s95
    v_lshlrev_b32 v3, 2, v1
    v_add_u32 v3, s94, v3
    s_lshl_b32 s95, s91, 3
    v_mov_b32 v4, s95
    ds_read_b64 v[72:73], v4 offset:2048
    ds_read_b64 v[74:75], v4 offset:2064
    ds_read_b64 v[76:77], v4 offset:2080
    ds_read_b64 v[78:79], v4 offset:2096
    ds_read_b64 v[80:81], v4 offset:2112
    ds_read_b64 v[82:83], v4 offset:2128
    ds_read_b64 v[84:85], v4 offset:2144
    ds_read_b64 v[86:87], v4 offset:2160
    ds_read_b64 v[88:89], v4 offset:2176
    ds_read_b64 v[90:91], v4 offset:2192
    ds_read_b32 v92, v3 offset:4096
    ds_read_b32 v93, v3 offset:6144
    ds_read_b32 v94, v3 offset:8192
    ds_read_b32 v95, v3 offset:10240
    ds_read_b32 v96, v3 offset:12288
    ds_read_b32 v97, v3 offset:14336
    ds_read_b32 v98, v3 offset:16384
    ds_read_b32 v99, v3 offset:18432
    ds_read_b32 v100, v3 offset:20480
    ds_read_b32 v101, v3 offset:22528
    s_cmp_eq_u32 s73, 1
    s_cselect_b64 s[96:97], -1, 0
    s_waitcnt lgkmcnt(0)
    v_max3_f32 v104, v72, v74, v76
    v_max3_f32 v104, v104, v78, v80
    v_max_f32 v104, v104, v82
    v_max3_f32 v105, v84, v86, v88
    v_max_f32 v105, v105, v90
    v_max_f32 v106, v104, v105
    v_cndmask_b32 v104, v106, v104, s[96:97]
    v_cndmask_b32 v105, v106, v105, s[96:97]
    v_sub_f32 v108, v72, v104
    v_sub_f32 v109, v74, v104
    v_sub_f32 v110, v76, v104
    v_sub_f32 v111, v78, v104
    v_sub_f32 v112, v80, v104
    v_sub_f32 v113, v82, v104
    v_sub_f32 v114, v84, v105
    v_sub_f32 v115, v86, v105
    v_sub_f32 v116, v88, v105
    v_sub_f32 v117, v90, v105
    v_exp_f32 v108, v108
    v_exp_f32 v109, v109
    v_exp_f32 v110, v110
    v_exp_f32 v111, v111
    v_exp_f32 v112, v112
    v_exp_f32 v113, v113
    v_exp_f32 v114, v114
    v_exp_f32 v115, v115
    v_exp_f32 v116, v116
    v_exp_f32 v117, v117
    s_nop 0
    v_mul_f32 v120, v108, v92
    v_mul_f32 v122, v108, v73
    v_fmac_f32 v120, v109, v93
    v_fmac_f32 v122, v109, v75
    v_fmac_f32 v120, v110, v94
    v_fmac_f32 v122, v110, v77
    v_fmac_f32 v120, v111, v95
    v_fmac_f32 v122, v111, v79
    v_fmac_f32 v120, v112, v96
    v_fmac_f32 v122, v112, v81
    v_fmac_f32 v120, v113, v97
    v_fmac_f32 v122, v113, v83
    v_mul_f32 v121, v114, v98
    v_mul_f32 v123, v114, v85
    v_fmac_f32 v121, v115, v99
    v_fmac_f32 v123, v115, v87
    v_fmac_f32 v121, v116, v100
    v_fmac_f32 v123, v116, v89
    v_fmac_f32 v121, v117, v101
    v_fmac_f32 v123, v117, v91
    v_add_f32 v124, v120, v121
    v_add_f32 v125, v122, v123
    v_cndmask_b32 v120, v124, v120, s[96:97]
    v_cndmask_b32 v122, v125, v122, s[96:97]
    v_mov_b32 v126, 0x7fc00000
    v_cmp_o_f32 vcc, v120, v120
    v_cndmask_b32 v120, v126, v120, vcc
    v_cmp_o_f32 vcc, v121, v121
    v_cndmask_b32 v121, v126, v121, vcc
    v_cmp_o_f32 vcc, v104, v104
    v_cndmask_b32 v104, v126, v104, vcc
    v_cmp_o_f32 vcc, v122, v122
    v_cndmask_b32 v122, v126, v122, vcc
    v_cmp_o_f32 vcc, v105, v105
    v_cndmask_b32 v105, v126, v105, vcc
    v_cmp_o_f32 vcc, v123, v123
    v_cndmask_b32 v123, v126, v123, vcc
    s_mul_i32 s95, s91, 1280
    s_lshl_b32 s98, s93, 8
    s_add_u32 s95, s95, s98
    v_lshlrev_b32 v5, 2, v1
    v_add_u32 v5, s95, v5
    buffer_store_dword v120, v5, s[32:35], s76 offen sc1
    v_mov_b32 v128, v104
    v_mov_b32 v129, v122
    s_mul_i32 s98, s91, 1280
    v_mov_b32 v6, s98
    s_cmp_eq_u32 s93, 0
    s_cselect_b64 s[98:99], 1, 0
    s_mov_b64 exec, s[98:99]
    s_cbranch_execz .Lc_noml0
    buffer_store_dwordx2 v[128:129], v6, s[32:35], s76 offen offset:1024 sc1
.Lc_noml0:
    s_mov_b64 exec, -1
    s_cmp_eq_u32 s73, 1
    s_cbranch_scc0 .Lc_noseg1
    buffer_store_dword v121, v5, s[32:35], s77 offen sc1
    v_mov_b32 v130, v105
    v_mov_b32 v131, v123
    s_mov_b64 exec, s[98:99]
    s_cbranch_execz .Lc_noml1
    buffer_store_dwordx2 v[130:131], v6, s[32:35], s77 offen offset:1024 sc1
.Lc_noml1:
    s_mov_b64 exec, -1
.Lc_noseg1:
    s_barrier
    s_lshl_b32 s91, s78, 4
    s_add_u32 s91, s91, 2432
    v_mov_b32 v3, s91
    ds_read_b128 v[72:75], v3
    s_waitcnt lgkmcnt(0)
    v_readfirstlane_b32 s94, v72
    v_readfirstlane_b32 s96, v73
    v_readfirstlane_b32 s98, v74
    v_readfirstlane_b32 s100, v75
    s_nop 3
    s_lshl_b32 s95, s94, 16
    s_lshl_b32 s97, s96, 16
    s_lshl_b32 s99, s98, 16
    s_lshl_b32 s101, s100, 16
    s_waitcnt vmcnt(0)
    v_dot2_f32_bf16 v96, v8, s94, 0
    v_dot2_f32_bf16 v97, v8, s95, 0
    v_dot2_f32_bf16 v98, v9, s94, 0
    v_dot2_f32_bf16 v99, v9, s95, 0
    v_dot2_f32_bf16 v100, v10, s94, 0
    v_dot2_f32_bf16 v101, v10, s95, 0
    v_dot2_f32_bf16 v102, v11, s94, 0
    v_dot2_f32_bf16 v103, v11, s95, 0
    v_dot2_f32_bf16 v96, v12, s96, v96
    v_dot2_f32_bf16 v97, v12, s97, v97
    v_dot2_f32_bf16 v98, v13, s96, v98
    v_dot2_f32_bf16 v99, v13, s97, v99
    v_dot2_f32_bf16 v100, v14, s96, v100
    v_dot2_f32_bf16 v101, v14, s97, v101
    v_dot2_f32_bf16 v102, v15, s96, v102
    v_dot2_f32_bf16 v103, v15, s97, v103
    v_dot2_f32_bf16 v96, v16, s98, v96
    v_dot2_f32_bf16 v97, v16, s99, v97
    v_dot2_f32_bf16 v98, v17, s98, v98
    v_dot2_f32_bf16 v99, v17, s99, v99
    v_dot2_f32_bf16 v100, v18, s98, v100
    v_dot2_f32_bf16 v101, v18, s99, v101
    v_dot2_f32_bf16 v102, v19, s98, v102
    v_dot2_f32_bf16 v103, v19, s99, v103
    v_dot2_f32_bf16 v96, v20, s100, v96
    v_dot2_f32_bf16 v97, v20, s101, v97
    v_dot2_f32_bf16 v98, v21, s100, v98
    v_dot2_f32_bf16 v99, v21, s101, v99
    v_dot2_f32_bf16 v100, v22, s100, v100
    v_dot2_f32_bf16 v101, v22, s101, v101
    v_dot2_f32_bf16 v102, v23, s100, v102
    v_dot2_f32_bf16 v103, v23, s101, v103
    s_lshl_b32 s91, s78, 11
    v_lshlrev_b32 v3, 5, v1
    v_add_u32 v3, s91, v3
    s_nop 1
    ds_write_b128 v3, v[96:99] offset:24576
    ds_write_b128 v3, v[100:103] offset:24592
    s_waitcnt lgkmcnt(0)
    s_branch .Lc_b3
.Lc_skip_to_b3:
    s_barrier
.Lc_b3:
    s_barrier
    s_cmp_ge_u32 s78, 7
    s_cbranch_scc1 .Lc_after_y
    s_lshl_b32 s91, s78, 8
    v_lshlrev_b32 v3, 2, v1
    v_add_u32 v3, s91, v3
    ds_read_b32 v72, v3 offset:24576
    ds_read_b32 v73, v3 offset:26624
    ds_read_b32 v74, v3 offset:28672
    ds_read_b32 v75, v3 offset:30720
    ds_read_b32 v76, v3 offset:32768
    ds_read_b32 v77, v3 offset:34816
    ds_read_b32 v78, v3 offset:36864
    ds_read_b32 v79, v3 offset:38912
    s_mul_i32 s93, s2, 1792
    s_add_u32 s93, s93, 1376256
    v_mov_b32 v126, 0x7fc00000
    s_waitcnt lgkmcnt(0)
    v_add_f32 v72, v72, v73
    v_add_f32 v74, v74, v75
    v_add_f32 v76, v76, v77
    v_add_f32 v78, v78, v79
    v_add_f32 v72, v72, v74
    v_add_f32 v76, v76, v78
    v_add_f32 v72, v72, v76
    v_cmp_o_f32 vcc, v72, v72
    v_cndmask_b32 v72, v126, v72, vcc
    buffer_store_dword v72, v3, s[32:35], s93 offen sc1
.Lc_after_y:
    s_cmp_ge_u32 s2, 28
    s_cbranch_scc1 .Lend
    s_cmp_ge_u32 s78, 8
    s_cbranch_scc1 .Lc_skip_to_b4
    v_lshrrev_b32 v3, 2, v1
    v_mul_u32_u24 v3, 1792, v3
    v_and_b32 v4, 3, v1
    v_lshlrev_b32 v4, 4, v4
    v_add_u32 v3, v3, v4
    s_mul_i32 s91, s78, 57344
    s_lshl_b32 s93, s2, 6
    s_add_u32 s91, s91, s93
    s_add_u32 s91, s91, 1376256
    s_add_u32 s93, s91, 28672
    s_mov_b32 s90, 0
.Lc_poll4:
    buffer_load_dwordx4 v[72:75], v3, s[32:35], s91 offen sc1
    buffer_load_dwordx4 v[76:79], v3, s[32:35], s93 offen sc1
    s_waitcnt vmcnt(0)
    v_max3_u32 v80, v72, v73, v74
    v_max3_u32 v80, v80, v75, v76
    v_max3_u32 v80, v80, v77, v78
    v_max_u32 v80, v80, v79
    v_cmp_eq_u32 vcc, -1, v80
    s_cbranch_vccz .Lc_got4
    s_add_u32 s90, s90, 1
    s_cmp_lt_u32 s90, 131072
    s_cbranch_scc1 .Lc_poll4
.Lc_got4:
    v_add_f32 v72, v72, v76
    v_add_f32 v73, v73, v77
    v_add_f32 v74, v74, v78
    v_add_f32 v75, v75, v79
    s_nop 1
    v_permlane16_swap_b32 v72, v73
    v_permlane16_swap_b32 v74, v75
    v_add_f32 v72, v72, v73
    v_add_f32 v74, v74, v75
    s_nop 1
    v_permlane32_swap_b32 v72, v74
    v_add_f32 v72, v72, v74
    s_nop 1
    v_add_f32_dpp v76, v72, v72 row_shl:4 row_mask:0xf bank_mask:0x5
    v_add_f32_dpp v76, v72, v72 row_shr:4 row_mask:0xf bank_mask:0xa
    s_nop 1
    v_add_f32_dpp v72, v76, v76 row_ror:8 row_mask:0xf bank_mask:0xf
    v_lshrrev_b32 v4, 4, v1
    v_and_b32 v5, 3, v1
    v_lshl_add_u32 v4, v5, 2, v4
    v_lshlrev_b32 v4, 2, v4
    s_lshl_b32 s91, s78, 6
    v_add_u32 v4, s91, v4
    ds_write_b32 v4, v72 offset:2560
    s_waitcnt lgkmcnt(0)
.Lc_skip_to_b4:
    s_barrier
    s_cmp_lg_u32 s78, 0
    s_cbranch_scc1 .Lend
    v_lshlrev_b32 v3, 2, v1
    v_cmp_gt_u32 vcc, 16, v1
    s_and_saveexec_b64 s[96:97], vcc
    ds_read_b32 v8, v3 offset:2560
    ds_read_b32 v9, v3 offset:2624
    ds_read_b32 v10, v3 offset:2688
    ds_read_b32 v11, v3 offset:2752
    ds_read_b32 v12, v3 offset:2816
    ds_read_b32 v13, v3 offset:2880
    ds_read_b32 v14, v3 offset:2944
    ds_read_b32 v15, v3 offset:3008
    v_mov_b32 v4, 2320
    ds_read_b64 v[16:17], v4
    s_mov_b32 s60, s26
    s_mov_b32 s61, s27
    s_mov_b32 s62, 896
    s_mov_b32 s63, 0x20000
    s_waitcnt lgkmcnt(0)
    v_add_f32 v8, v8, v9
    v_add_f32 v10, v10, v11
    v_add_f32 v12, v12, v13
    v_add_f32 v14, v14, v15
    v_add_f32 v8, v8, v10
    v_add_f32 v12, v12, v14
    v_cvt_pk_bf16_f32 v18, v8, v8
    v_lshlrev_b32 v8, 16, v18
    v_cvt_pk_bf16_f32 v19, v12, v12
    v_lshlrev_b32 v12, 16, v19
    v_mul_f32 v8, v8, v16
    v_mul_f32 v12, v12, v17
    v_cvt_pk_bf16_f32 v18, v8, v8
    v_lshlrev_b32 v8, 16, v18
    v_cvt_pk_bf16_f32 v19, v12, v12
    v_lshlrev_b32 v12, 16, v19
    v_add_f32 v8, v8, v12
    v_cvt_pk_bf16_f32 v8, v8, v8
    v_lshlrev_b32 v3, 1, v1
    s_lshl_b32 s91, s2, 5
    buffer_store_short v8, v3, s[60:63], s91 offen
    s_mov_b64 exec, s[96:97]
    s_branch .Lend
.Lhelper:
    s_setprio 3
    v_mov_b32 v135, 0
    s_lshr_b32 s78, s72, 1
    s_and_b32 s79, s2, 1
    s_lshl_b32 s80, s71, 1
    s_add_u32 s80, s80, s79
    s_lshl_b32 s80, s80, 12
    s_lshl_b32 s81, s78, 6
    s_add_u32 s80, s80, s81
    s_lshl_b32 s80, s80, 2
    s_add_u32 s80, s80, 0
    v_mov_b32 v3, 2304
    v_mov_b32 v4, 0
    ds_write_b32 v3, v4
    v_mov_b32 v4, -1
    v_mov_b32 v5, -1
    v_mov_b32 v6, -1
    v_mov_b32 v7, -1
    v_cmp_gt_u32 vcc, 16, v1
    s_and_saveexec_b64 s[82:83], vcc
    buffer_store_dwordx4 v[4:7], v2, s[32:35], s80 offen sc1
    s_mov_b64 exec, s[82:83]
    buffer_store_dwordx4 v[4:7], v2, s[32:35], s76 offen sc1
    buffer_store_dwordx4 v[4:7], v2, s[32:35], s76 offen offset:1024 sc1
    v_cmp_gt_u32 vcc, 32, v1
    s_and_saveexec_b64 s[82:83], vcc
    buffer_store_dwordx4 v[4:7], v2, s[32:35], s76 offen offset:2048 sc1
    s_mov_b64 exec, s[82:83]
    s_mul_i32 s84, s2, 1792
    s_add_u32 s84, s84, 1376256
    buffer_store_dwordx4 v[4:7], v2, s[32:35], s84 offen sc1
    v_cmp_gt_u32 vcc, 48, v1
    s_and_saveexec_b64 s[82:83], vcc
    buffer_store_dwordx4 v[4:7], v2, s[32:35], s84 offen offset:1024 sc1
    s_mov_b64 exec, s[82:83]
    s_cmp_eq_u32 s73, 1
    s_cbranch_scc0 .Lh_noclr1
    buffer_store_dwordx4 v[4:7], v2, s[32:35], s77 offen sc1
    buffer_store_dwordx4 v[4:7], v2, s[32:35], s77 offen offset:1024 sc1
    v_cmp_gt_u32 vcc, 32, v1
    s_and_saveexec_b64 s[82:83], vcc
    buffer_store_dwordx4 v[4:7], v2, s[32:35], s77 offen offset:2048 sc1
    s_mov_b64 exec, s[82:83]
.Lh_noclr1:
    s_mov_b32 s52, s4
    s_mov_b32 s53, s5
    s_mov_b32 s54, 896
    s_mov_b32 s55, 0x20000
    s_cmp_eq_u32 s71, 0
    s_cselect_b64 s[48:49], s[10:11], s[20:21]
    s_mov_b32 s50, 3670016
    s_mov_b32 s51, 0x20000
    s_mov_b32 s64, s24
    s_mov_b32 s65, s25
    s_mov_b32 s66, 896
    s_mov_b32 s67, 0x20000
    v_lshrrev_b32 v3, 3, v1
    v_mul_u32_u24 v134, 56, v3
    s_mul_i32 s85, s79, 448
    buffer_load_dwordx2 v[120:121], v134, s[52:55], s85 offen offset:0
    buffer_load_dwordx2 v[122:123], v134, s[52:55], s85 offen offset:8
    buffer_load_dwordx2 v[124:125], v134, s[52:55], s85 offen offset:16
    buffer_load_dwordx2 v[126:127], v134, s[52:55], s85 offen offset:24
    buffer_load_dwordx2 v[128:129], v134, s[52:55], s85 offen offset:32
    buffer_load_dwordx2 v[130:131], v134, s[52:55], s85 offen offset:40
    buffer_load_dwordx2 v[132:133], v134, s[52:55], s85 offen offset:48
    v_lshrrev_b32 v3, 3, v1
    s_mov_b32 s86, 229376
    v_mul_lo_u32 v3, v3, s86
    v_and_b32 v9, 7, v1
    v_lshl_add_u32 v3, v9, 4, v3
    s_mul_i32 s86, s79, 1835008
    s_lshl_b32 s87, s78, 7
    s_add_u32 s86, s86, s87
    buffer_load_dwordx4 v[8:11], v3, s[48:51], s86 offen nt
    s_add_u32 s86, s86, 8192
    buffer_load_dwordx4 v[12:15], v3, s[48:51], s86 offen nt
    s_add_u32 s86, s86, 8192
    buffer_load_dwordx4 v[16:19], v3, s[48:51], s86 offen nt
    s_add_u32 s86, s86, 8192
    buffer_load_dwordx4 v[20:23], v3, s[48:51], s86 offen nt
    s_add_u32 s86, s86, 8192
    buffer_load_dwordx4 v[24:27], v3, s[48:51], s86 offen nt
    s_add_u32 s86, s86, 8192
    buffer_load_dwordx4 v[28:31], v3, s[48:51], s86 offen nt
    s_add_u32 s86, s86, 8192
    buffer_load_dwordx4 v[32:35], v3, s[48:51], s86 offen nt
    s_add_u32 s86, s86, 8192
    buffer_load_dwordx4 v[36:39], v3, s[48:51], s86 offen nt
    s_add_u32 s86, s86, 8192
    buffer_load_dwordx4 v[40:43], v3, s[48:51], s86 offen nt
    s_add_u32 s86, s86, 8192
    buffer_load_dwordx4 v[44:47], v3, s[48:51], s86 offen nt
    s_add_u32 s86, s86, 8192
    buffer_load_dwordx4 v[48:51], v3, s[48:51], s86 offen nt
    s_add_u32 s86, s86, 8192
    buffer_load_dwordx4 v[52:55], v3, s[48:51], s86 offen nt
    s_add_u32 s86, s86, 8192
    buffer_load_dwordx4 v[56:59], v3, s[48:51], s86 offen nt
    s_add_u32 s86, s86, 8192
    buffer_load_dwordx4 v[60:63], v3, s[48:51], s86 offen nt
    s_add_u32 s86, s86, 8192
    buffer_load_dwordx4 v[64:67], v3, s[48:51], s86 offen nt
    s_add_u32 s86, s86, 8192
    buffer_load_dwordx4 v[68:71], v3, s[48:51], s86 offen nt
    s_add_u32 s86, s86, 8192
    buffer_load_dwordx4 v[72:75], v3, s[48:51], s86 offen nt
    s_add_u32 s86, s86, 8192
    buffer_load_dwordx4 v[76:79], v3, s[48:51], s86 offen nt
    s_add_u32 s86, s86, 8192
    buffer_load_dwordx4 v[80:83], v3, s[48:51], s86 offen nt
    s_add_u32 s86, s86, 8192
    buffer_load_dwordx4 v[84:87], v3, s[48:51], s86 offen nt
    s_add_u32 s86, s86, 8192
    buffer_load_dwordx4 v[88:91], v3, s[48:51], s86 offen nt
    s_add_u32 s86, s86, 8192
    buffer_load_dwordx4 v[92:95], v3, s[48:51], s86 offen nt
    s_add_u32 s86, s86, 8192
    buffer_load_dwordx4 v[96:99], v3, s[48:51], s86 offen nt
    s_add_u32 s86, s86, 8192
    buffer_load_dwordx4 v[100:103], v3, s[48:51], s86 offen nt
    s_add_u32 s86, s86, 8192
    buffer_load_dwordx4 v[104:107], v3, s[48:51], s86 offen nt
    s_add_u32 s86, s86, 8192
    buffer_load_dwordx4 v[108:111], v3, s[48:51], s86 offen nt
    s_add_u32 s86, s86, 8192
    buffer_load_dwordx4 v[112:115], v3, s[48:51], s86 offen nt
    s_add_u32 s86, s86, 8192
    buffer_load_dwordx4 v[116:119], v3, s[48:51], s86 offen nt
    buffer_load_dwordx4 v[136:139], v2, s[52:55], 0 offen
    buffer_load_dwordx4 v[140:143], v2, s[64:67], 0 offen
    s_waitcnt lgkmcnt(0)
    s_barrier
    s_waitcnt vmcnt(37)
    v_mov_b32 v4, 1
    s_and_b32 s89, s2, 3
    s_lshl_b32 s89, s89, 6
    v_mov_b32 v5, 0
    s_mov_b64 exec, 1
    buffer_atomic_add v4, v5, s[56:59], s89 offen
    s_mov_b64 exec, -1
    s_waitcnt vmcnt(27)
    v_and_b32 v152, 0xffff, v120
    v_lshlrev_b32 v153, 16, v120
    s_nop 0
    v_dot2_f32_bf16 v144, v8, v152, 0
    v_dot2_f32_bf16 v145, v8, v153, 0
    v_dot2_f32_bf16 v146, v9, v152, 0
    v_dot2_f32_bf16 v147, v9, v153, 0
    v_dot2_f32_bf16 v148, v10, v152, 0
    v_dot2_f32_bf16 v149, v10, v153, 0
    v_dot2_f32_bf16 v150, v11, v152, 0
    v_dot2_f32_bf16 v151, v11, v153, 0
    v_lshrrev_b32 v152, 16, v120
    v_and_b32 v153, 0xffff0000, v120
    s_nop 0
    v_dot2c_f32_bf16 v144, v12, v152
    v_dot2c_f32_bf16 v145, v12, v153
    v_dot2c_f32_bf16 v146, v13, v152
    v_dot2c_f32_bf16 v147, v13, v153
    v_dot2c_f32_bf16 v148, v14, v152
    v_dot2c_f32_bf16 v149, v14, v153
    v_dot2c_f32_bf16 v150, v15, v152
    v_dot2c_f32_bf16 v151, v15, v153
    v_and_b32 v152, 0xffff, v121
    v_lshlrev_b32 v153, 16, v121
    s_nop 0
    v_dot2c_f32_bf16 v144, v16, v152
    v_dot2c_f32_bf16 v145, v16, v153
    v_dot2c_f32_bf16 v146, v17, v152
    v_dot2c_f32_bf16 v147, v17, v153
    v_dot2c_f32_bf16 v148, v18, v152
    v_dot2c_f32_bf16 v149, v18, v153
    v_dot2c_f32_bf16 v150, v19, v152
    v_dot2c_f32_bf16 v151, v19, v153
    v_lshrrev_b32 v152, 16, v121
    v_and_b32 v153, 0xffff0000, v121
    s_nop 0
    v_dot2c_f32_bf16 v144, v20, v152
    v_dot2c_f32_bf16 v145, v20, v153
    v_dot2c_f32_bf16 v146, v21, v152
    v_dot2c_f32_bf16 v147, v21, v153
    v_dot2c_f32_bf16 v148, v22, v152
    v_dot2c_f32_bf16 v149, v22, v153
    v_dot2c_f32_bf16 v150, v23, v152
    v_dot2c_f32_bf16 v151, v23, v153
    s_waitcnt vmcnt(23)
    v_and_b32 v152, 0xffff, v122
    v_lshlrev_b32 v153, 16, v122
    s_nop 0
    v_dot2c_f32_bf16 v144, v24, v152
    v_dot2c_f32_bf16 v145, v24, v153
    v_dot2c_f32_bf16 v146, v25, v152
    v_dot2c_f32_bf16 v147, v25, v153
    v_dot2c_f32_bf16 v148, v26, v152
    v_dot2c_f32_bf16 v149, v26, v153
    v_dot2c_f32_bf16 v150, v27, v152
    v_dot2c_f32_bf16 v151, v27, v153
    v_lshrrev_b32 v152, 16, v122
    v_and_b32 v153, 0xffff0000, v122
    s_nop 0
    v_dot2c_f32_bf16 v144, v28, v152
    v_dot2c_f32_bf16 v145, v28, v153
    v_dot2c_f32_bf16 v146, v29, v152
    v_dot2c_f32_bf16 v147, v29, v153
    v_dot2c_f32_bf16 v148, v30, v152
    v_dot2c_f32_bf16 v149, v30, v153
    v_dot2c_f32_bf16 v150, v31, v152
    v_dot2c_f32_bf16 v151, v31, v153
    v_and_b32 v152, 0xffff, v123
    v_lshlrev_b32 v153, 16, v123
    s_nop 0
    v_dot2c_f32_bf16 v144, v32, v152
    v_dot2c_f32_bf16 v145, v32, v153
    v_dot2c_f32_bf16 v146, v33, v152
    v_dot2c_f32_bf16 v147, v33, v153
    v_dot2c_f32_bf16 v148, v34, v152
    v_dot2c_f32_bf16 v149, v34, v153
    v_dot2c_f32_bf16 v150, v35, v152
    v_dot2c_f32_bf16 v151, v35, v153
    v_lshrrev_b32 v152, 16, v123
    v_and_b32 v153, 0xffff0000, v123
    s_nop 0
    v_dot2c_f32_bf16 v144, v36, v152
    v_dot2c_f32_bf16 v145, v36, v153
    v_dot2c_f32_bf16 v146, v37, v152
    v_dot2c_f32_bf16 v147, v37, v153
    v_dot2c_f32_bf16 v148, v38, v152
    v_dot2c_f32_bf16 v149, v38, v153
    v_dot2c_f32_bf16 v150, v39, v152
    v_dot2c_f32_bf16 v151, v39, v153
    s_waitcnt vmcnt(19)
    v_and_b32 v152, 0xffff, v124
    v_lshlrev_b32 v153, 16, v124
    s_nop 0
    v_dot2c_f32_bf16 v144, v40, v152
    v_dot2c_f32_bf16 v145, v40, v153
    v_dot2c_f32_bf16 v146, v41, v152
    v_dot2c_f32_bf16 v147, v41, v153
    v_dot2c_f32_bf16 v148, v42, v152
    v_dot2c_f32_bf16 v149, v42, v153
    v_dot2c_f32_bf16 v150, v43, v152
    v_dot2c_f32_bf16 v151, v43, v153
    v_lshrrev_b32 v152, 16, v124
    v_and_b32 v153, 0xffff0000, v124
    s_nop 0
    v_dot2c_f32_bf16 v144, v44, v152
    v_dot2c_f32_bf16 v145, v44, v153
    v_dot2c_f32_bf16 v146, v45, v152
    v_dot2c_f32_bf16 v147, v45, v153
    v_dot2c_f32_bf16 v148, v46, v152
    v_dot2c_f32_bf16 v149, v46, v153
    v_dot2c_f32_bf16 v150, v47, v152
    v_dot2c_f32_bf16 v151, v47, v153
    v_and_b32 v152, 0xffff, v125
    v_lshlrev_b32 v153, 16, v125
    s_nop 0
    v_dot2c_f32_bf16 v144, v48, v152
    v_dot2c_f32_bf16 v145, v48, v153
    v_dot2c_f32_bf16 v146, v49, v152
    v_dot2c_f32_bf16 v147, v49, v153
    v_dot2c_f32_bf16 v148, v50, v152
    v_dot2c_f32_bf16 v149, v50, v153
    v_dot2c_f32_bf16 v150, v51, v152
    v_dot2c_f32_bf16 v151, v51, v153
    v_lshrrev_b32 v152, 16, v125
    v_and_b32 v153, 0xffff0000, v125
    s_nop 0
    v_dot2c_f32_bf16 v144, v52, v152
    v_dot2c_f32_bf16 v145, v52, v153
    v_dot2c_f32_bf16 v146, v53, v152
    v_dot2c_f32_bf16 v147, v53, v153
    v_dot2c_f32_bf16 v148, v54, v152
    v_dot2c_f32_bf16 v149, v54, v153
    v_dot2c_f32_bf16 v150, v55, v152
    v_dot2c_f32_bf16 v151, v55, v153
    s_waitcnt vmcnt(15)
    v_and_b32 v152, 0xffff, v126
    v_lshlrev_b32 v153, 16, v126
    s_nop 0
    v_dot2c_f32_bf16 v144, v56, v152
    v_dot2c_f32_bf16 v145, v56, v153
    v_dot2c_f32_bf16 v146, v57, v152
    v_dot2c_f32_bf16 v147, v57, v153
    v_dot2c_f32_bf16 v148, v58, v152
    v_dot2c_f32_bf16 v149, v58, v153
    v_dot2c_f32_bf16 v150, v59, v152
    v_dot2c_f32_bf16 v151, v59, v153
    v_lshrrev_b32 v152, 16, v126
    v_and_b32 v153, 0xffff0000, v126
    s_nop 0
    v_dot2c_f32_bf16 v144, v60, v152
    v_dot2c_f32_bf16 v145, v60, v153
    v_dot2c_f32_bf16 v146, v61, v152
    v_dot2c_f32_bf16 v147, v61, v153
    v_dot2c_f32_bf16 v148, v62, v152
    v_dot2c_f32_bf16 v149, v62, v153
    v_dot2c_f32_bf16 v150, v63, v152
    v_dot2c_f32_bf16 v151, v63, v153
    v_and_b32 v152, 0xffff, v127
    v_lshlrev_b32 v153, 16, v127
    s_nop 0
    v_dot2c_f32_bf16 v144, v64, v152
    v_dot2c_f32_bf16 v145, v64, v153
    v_dot2c_f32_bf16 v146, v65, v152
    v_dot2c_f32_bf16 v147, v65, v153
    v_dot2c_f32_bf16 v148, v66, v152
    v_dot2c_f32_bf16 v149, v66, v153
    v_dot2c_f32_bf16 v150, v67, v152
    v_dot2c_f32_bf16 v151, v67, v153
    v_lshrrev_b32 v152, 16, v127
    v_and_b32 v153, 0xffff0000, v127
    s_nop 0
    v_dot2c_f32_bf16 v144, v68, v152
    v_dot2c_f32_bf16 v145, v68, v153
    v_dot2c_f32_bf16 v146, v69, v152
    v_dot2c_f32_bf16 v147, v69, v153
    v_dot2c_f32_bf16 v148, v70, v152
    v_dot2c_f32_bf16 v149, v70, v153
    v_dot2c_f32_bf16 v150, v71, v152
    v_dot2c_f32_bf16 v151, v71, v153
    s_waitcnt vmcnt(11)
    v_and_b32 v152, 0xffff, v128
    v_lshlrev_b32 v153, 16, v128
    s_nop 0
    v_dot2c_f32_bf16 v144, v72, v152
    v_dot2c_f32_bf16 v145, v72, v153
    v_dot2c_f32_bf16 v146, v73, v152
    v_dot2c_f32_bf16 v147, v73, v153
    v_dot2c_f32_bf16 v148, v74, v152
    v_dot2c_f32_bf16 v149, v74, v153
    v_dot2c_f32_bf16 v150, v75, v152
    v_dot2c_f32_bf16 v151, v75, v153
    v_lshrrev_b32 v152, 16, v128
    v_and_b32 v153, 0xffff0000, v128
    s_nop 0
    v_dot2c_f32_bf16 v144, v76, v152
    v_dot2c_f32_bf16 v145, v76, v153
    v_dot2c_f32_bf16 v146, v77, v152
    v_dot2c_f32_bf16 v147, v77, v153
    v_dot2c_f32_bf16 v148, v78, v152
    v_dot2c_f32_bf16 v149, v78, v153
    v_dot2c_f32_bf16 v150, v79, v152
    v_dot2c_f32_bf16 v151, v79, v153
    v_and_b32 v152, 0xffff, v129
    v_lshlrev_b32 v153, 16, v129
    s_nop 0
    v_dot2c_f32_bf16 v144, v80, v152
    v_dot2c_f32_bf16 v145, v80, v153
    v_dot2c_f32_bf16 v146, v81, v152
    v_dot2c_f32_bf16 v147, v81, v153
    v_dot2c_f32_bf16 v148, v82, v152
    v_dot2c_f32_bf16 v149, v82, v153
    v_dot2c_f32_bf16 v150, v83, v152
    v_dot2c_f32_bf16 v151, v83, v153
    v_lshrrev_b32 v152, 16, v129
    v_and_b32 v153, 0xffff0000, v129
    s_nop 0
    v_dot2c_f32_bf16 v144, v84, v152
    v_dot2c_f32_bf16 v145, v84, v153
    v_dot2c_f32_bf16 v146, v85, v152
    v_dot2c_f32_bf16 v147, v85, v153
    v_dot2c_f32_bf16 v148, v86, v152
    v_dot2c_f32_bf16 v149, v86, v153
    v_dot2c_f32_bf16 v150, v87, v152
    v_dot2c_f32_bf16 v151, v87, v153
    s_waitcnt vmcnt(7)
    v_and_b32 v152, 0xffff, v130
    v_lshlrev_b32 v153, 16, v130
    s_nop 0
    v_dot2c_f32_bf16 v144, v88, v152
    v_dot2c_f32_bf16 v145, v88, v153
    v_dot2c_f32_bf16 v146, v89, v152
    v_dot2c_f32_bf16 v147, v89, v153
    v_dot2c_f32_bf16 v148, v90, v152
    v_dot2c_f32_bf16 v149, v90, v153
    v_dot2c_f32_bf16 v150, v91, v152
    v_dot2c_f32_bf16 v151, v91, v153
    v_lshrrev_b32 v152, 16, v130
    v_and_b32 v153, 0xffff0000, v130
    s_nop 0
    v_dot2c_f32_bf16 v144, v92, v152
    v_dot2c_f32_bf16 v145, v92, v153
    v_dot2c_f32_bf16 v146, v93, v152
    v_dot2c_f32_bf16 v147, v93, v153
    v_dot2c_f32_bf16 v148, v94, v152
    v_dot2c_f32_bf16 v149, v94, v153
    v_dot2c_f32_bf16 v150, v95, v152
    v_dot2c_f32_bf16 v151, v95, v153
    v_and_b32 v152, 0xffff, v131
    v_lshlrev_b32 v153, 16, v131
    s_nop 0
    v_dot2c_f32_bf16 v144, v96, v152
    v_dot2c_f32_bf16 v145, v96, v153
    v_dot2c_f32_bf16 v146, v97, v152
    v_dot2c_f32_bf16 v147, v97, v153
    v_dot2c_f32_bf16 v148, v98, v152
    v_dot2c_f32_bf16 v149, v98, v153
    v_dot2c_f32_bf16 v150, v99, v152
    v_dot2c_f32_bf16 v151, v99, v153
    v_lshrrev_b32 v152, 16, v131
    v_and_b32 v153, 0xffff0000, v131
    s_nop 0
    v_dot2c_f32_bf16 v144, v100, v152
    v_dot2c_f32_bf16 v145, v100, v153
    v_dot2c_f32_bf16 v146, v101, v152
    v_dot2c_f32_bf16 v147, v101, v153
    v_dot2c_f32_bf16 v148, v102, v152
    v_dot2c_f32_bf16 v149, v102, v153
    v_dot2c_f32_bf16 v150, v103, v152
    v_dot2c_f32_bf16 v151, v103, v153
    s_waitcnt vmcnt(3)
    v_and_b32 v152, 0xffff, v132
    v_lshlrev_b32 v153, 16, v132
    s_nop 0
    v_dot2c_f32_bf16 v144, v104, v152
    v_dot2c_f32_bf16 v145, v104, v153
    v_dot2c_f32_bf16 v146, v105, v152
    v_dot2c_f32_bf16 v147, v105, v153
    v_dot2c_f32_bf16 v148, v106, v152
    v_dot2c_f32_bf16 v149, v106, v153
    v_dot2c_f32_bf16 v150, v107, v152
    v_dot2c_f32_bf16 v151, v107, v153
    v_lshrrev_b32 v152, 16, v132
    v_and_b32 v153, 0xffff0000, v132
    s_nop 0
    v_dot2c_f32_bf16 v144, v108, v152
    v_dot2c_f32_bf16 v145, v108, v153
    v_dot2c_f32_bf16 v146, v109, v152
    v_dot2c_f32_bf16 v147, v109, v153
    v_dot2c_f32_bf16 v148, v110, v152
    v_dot2c_f32_bf16 v149, v110, v153
    v_dot2c_f32_bf16 v150, v111, v152
    v_dot2c_f32_bf16 v151, v111, v153
    v_and_b32 v152, 0xffff, v133
    v_lshlrev_b32 v153, 16, v133
    s_nop 0
    v_dot2c_f32_bf16 v144, v112, v152
    v_dot2c_f32_bf16 v145, v112, v153
    v_dot2c_f32_bf16 v146, v113, v152
    v_dot2c_f32_bf16 v147, v113, v153
    v_dot2c_f32_bf16 v148, v114, v152
    v_dot2c_f32_bf16 v149, v114, v153
    v_dot2c_f32_bf16 v150, v115, v152
    v_dot2c_f32_bf16 v151, v115, v153
    v_lshrrev_b32 v152, 16, v133
    v_and_b32 v153, 0xffff0000, v133
    s_nop 0
    v_dot2c_f32_bf16 v144, v116, v152
    v_dot2c_f32_bf16 v145, v116, v153
    v_dot2c_f32_bf16 v146, v117, v152
    v_dot2c_f32_bf16 v147, v117, v153
    v_dot2c_f32_bf16 v148, v118, v152
    v_dot2c_f32_bf16 v149, v118, v153
    v_dot2c_f32_bf16 v150, v119, v152
    v_dot2c_f32_bf16 v151, v119, v153
    s_nop 3
    v_add_f32_dpp v144, v144, v144 row_ror:8 row_mask:0xf bank_mask:0x3
    v_add_f32_dpp v146, v146, v146 row_ror:8 row_mask:0xf bank_mask:0x3
    v_add_f32_dpp v148, v148, v148 row_ror:8 row_mask:0xf bank_mask:0x3
    v_add_f32_dpp v150, v150, v150 row_ror:8 row_mask:0xf bank_mask:0x3
    v_add_f32_dpp v144, v145, v145 row_ror:8 row_mask:0xf bank_mask:0xc
    v_add_f32_dpp v146, v147, v147 row_ror:8 row_mask:0xf bank_mask:0xc
    v_add_f32_dpp v148, v149, v149 row_ror:8 row_mask:0xf bank_mask:0xc
    v_add_f32_dpp v150, v151, v151 row_ror:8 row_mask:0xf bank_mask:0xc
    s_nop 1
    v_permlane16_swap_b32 v144, v146
    v_permlane16_swap_b32 v148, v150
    v_add_f32 v144, v144, v146
    v_add_f32 v148, v148, v150
    s_nop 1
    v_permlane32_swap_b32 v144, v148
    v_add_f32 v144, v144, v148
    v_mov_b32 v154, 0x7fc00000
    v_cmp_o_f32 vcc, v144, v144
    v_cndmask_b32 v144, v154, v144, vcc
    v_and_b32 v3, 7, v1
    v_lshrrev_b32 v9, 3, v1
    v_lshl_add_u32 v3, v3, 3, v9
    v_lshlrev_b32 v3, 2, v3
    buffer_store_dword v144, v3, s[32:35], s80 offen sc1
    s_mov_b32 s90, 0
    v_and_b32 v5, 3, v1
    v_lshlrev_b32 v5, 6, v5
.Lh_pollinit:
    buffer_load_dword v4, v5, s[56:59], 0 offen sc1
    s_waitcnt vmcnt(0)
.Lh_chkinit:
    s_nop 1
    v_readlane_b32 s91, v4, 0
    v_readlane_b32 s92, v4, 1
    v_readlane_b32 s93, v4, 2
    v_readlane_b32 s94, v4, 3
    s_nop 3
    s_add_u32 s91, s91, s92
    s_add_u32 s93, s93, s94
    s_add_u32 s91, s91, s93
    s_cmp_ge_u32 s91, 256
    s_cbranch_scc1 .Lh_gotinit
    s_sleep 1
    s_add_u32 s90, s90, 1
    s_cmp_lt_u32 s90, 131072
    s_cbranch_scc1 .Lh_pollinit
.Lh_gotinit:
    s_lshr_b32 s91, s74, 3
    s_lshl_b32 s91, s91, 15
    s_lshl_b32 s93, s69, 11
    s_add_u32 s91, s91, s93
    s_add_u32 s91, s91, 0
    s_mov_b32 s90, 0
    s_add_u32 s92, s91, 16384
.Lh_pollq_1:
    buffer_load_dwordx4 v[8:11], v2, s[32:35], s91 offen sc1
    buffer_load_dwordx4 v[12:15], v2, s[32:35], s91 offen offset:1024 sc1
    buffer_load_dwordx4 v[16:19], v2, s[32:35], s92 offen sc1
    buffer_load_dwordx4 v[20:23], v2, s[32:35], s92 offen offset:1024 sc1
    s_waitcnt vmcnt(0)
    v_max3_u32 v24, v8, v9, v10
    v_max3_u32 v24, v24, v11, v12
    v_max3_u32 v24, v24, v13, v14
    v_max3_u32 v24, v24, v15, v16
    v_max3_u32 v24, v24, v17, v18
    v_max3_u32 v24, v24, v19, v20
    v_max3_u32 v24, v24, v21, v22
    v_max_u32 v24, v24, v23
    v_cmp_eq_u32 vcc, -1, v24
    s_cbranch_vccz .Lh_gotq_2
    s_sleep 1
    s_add_u32 s90, s90, 1
    s_cmp_lt_u32 s90, 131072
    s_cbranch_scc1 .Lh_pollq_1
.Lh_gotq_2:
    v_add_f32 v8, v8, v16
    v_add_f32 v12, v12, v20
    v_add_f32 v9, v9, v17
    v_add_f32 v13, v13, v21
    v_add_f32 v10, v10, v18
    v_add_f32 v14, v14, v22
    v_add_f32 v11, v11, v19
    v_add_f32 v15, v15, v23
    v_cvt_pk_bf16_f32 v24, v8, v9
    v_cvt_pk_bf16_f32 v25, v10, v11
    v_cvt_pk_bf16_f32 v26, v12, v13
    v_cvt_pk_bf16_f32 v27, v14, v15
    v_lshlrev_b32 v28, 3, v1
    s_nop 0
    ds_write_b64 v28, v[24:25] offset:0
    ds_write_b64 v28, v[26:27] offset:512
    s_cmp_eq_u32 s73, 1
    s_cbranch_scc0 .Lh_noq1
    s_lshl_b32 s91, s69, 11
    s_add_u32 s91, s91, 0
    s_mov_b32 s90, 0
    s_add_u32 s92, s91, 16384
.Lh_pollq_3:
    buffer_load_dwordx4 v[8:11], v2, s[32:35], s91 offen sc1
    buffer_load_dwordx4 v[12:15], v2, s[32:35], s91 offen offset:1024 sc1
    buffer_load_dwordx4 v[16:19], v2, s[32:35], s92 offen sc1
    buffer_load_dwordx4 v[20:23], v2, s[32:35], s92 offen offset:1024 sc1
    s_waitcnt vmcnt(0)
    v_max3_u32 v24, v8, v9, v10
    v_max3_u32 v24, v24, v11, v12
    v_max3_u32 v24, v24, v13, v14
    v_max3_u32 v24, v24, v15, v16
    v_max3_u32 v24, v24, v17, v18
    v_max3_u32 v24, v24, v19, v20
    v_max3_u32 v24, v24, v21, v22
    v_max_u32 v24, v24, v23
    v_cmp_eq_u32 vcc, -1, v24
    s_cbranch_vccz .Lh_gotq_4
    s_sleep 1
    s_add_u32 s90, s90, 1
    s_cmp_lt_u32 s90, 131072
    s_cbranch_scc1 .Lh_pollq_3
.Lh_gotq_4:
    v_add_f32 v8, v8, v16
    v_add_f32 v12, v12, v20
    v_add_f32 v9, v9, v17
    v_add_f32 v13, v13, v21
    v_add_f32 v10, v10, v18
    v_add_f32 v14, v14, v22
    v_add_f32 v11, v11, v19
    v_add_f32 v15, v15, v23
    v_cvt_pk_bf16_f32 v24, v8, v9
    v_cvt_pk_bf16_f32 v25, v10, v11
    v_cvt_pk_bf16_f32 v26, v12, v13
    v_cvt_pk_bf16_f32 v27, v14, v15
    v_lshlrev_b32 v28, 3, v1
    s_nop 0
    ds_write_b64 v28, v[24:25] offset:1024
    ds_write_b64 v28, v[26:27] offset:1536
.Lh_noq1:
    s_waitcnt lgkmcnt(0)
    v_mov_b32 v3, 2304
    v_mov_b32 v4, 1
    ds_write_b32 v3, v4
    s_waitcnt vmcnt(0)
    v_mov_b32 v156, 0
    v_lshlrev_b32 v157, 16, v136
    v_and_b32 v158, 0xffff0000, v136
    v_lshlrev_b32 v159, 16, v140
    v_and_b32 v160, 0xffff0000, v140
    v_mul_f32 v157, v157, v159
    v_mul_f32 v158, v158, v160
    v_cvt_pk_bf16_f32 v157, v157, v158
    s_nop 0
    v_lshlrev_b32 v158, 16, v157
    v_and_b32 v159, 0xffff0000, v157
    v_add_f32 v156, v156, v158
    v_add_f32 v156, v156, v159
    v_lshlrev_b32 v157, 16, v137
    v_and_b32 v158, 0xffff0000, v137
    v_lshlrev_b32 v159, 16, v141
    v_and_b32 v160, 0xffff0000, v141
    v_mul_f32 v157, v157, v159
    v_mul_f32 v158, v158, v160
    v_cvt_pk_bf16_f32 v157, v157, v158
    s_nop 0
    v_lshlrev_b32 v158, 16, v157
    v_and_b32 v159, 0xffff0000, v157
    v_add_f32 v156, v156, v158
    v_add_f32 v156, v156, v159
    v_lshlrev_b32 v157, 16, v138
    v_and_b32 v158, 0xffff0000, v138
    v_lshlrev_b32 v159, 16, v142
    v_and_b32 v160, 0xffff0000, v142
    v_mul_f32 v157, v157, v159
    v_mul_f32 v158, v158, v160
    v_cvt_pk_bf16_f32 v157, v157, v158
    s_nop 0
    v_lshlrev_b32 v158, 16, v157
    v_and_b32 v159, 0xffff0000, v157
    v_add_f32 v156, v156, v158
    v_add_f32 v156, v156, v159
    v_lshlrev_b32 v157, 16, v139
    v_and_b32 v158, 0xffff0000, v139
    v_lshlrev_b32 v159, 16, v143
    v_and_b32 v160, 0xffff0000, v143
    v_mul_f32 v157, v157, v159
    v_mul_f32 v158, v158, v160
    v_cvt_pk_bf16_f32 v157, v157, v158
    s_nop 0
    v_lshlrev_b32 v158, 16, v157
    v_and_b32 v159, 0xffff0000, v157
    v_add_f32 v156, v156, v158
    v_add_f32 v156, v156, v159
    s_nop 1
    v_add_f32_dpp v156, v156, v156 row_shr:1 row_mask:0xf bank_mask:0xf bound_ctrl:0
    s_nop 1
    v_add_f32_dpp v156, v156, v156 row_shr:2 row_mask:0xf bank_mask:0xf bound_ctrl:0
    s_nop 1
    v_add_f32_dpp v156, v156, v156 row_shr:4 row_mask:0xf bank_mask:0xf bound_ctrl:0
    s_nop 1
    v_add_f32_dpp v156, v156, v156 row_shr:8 row_mask:0xf bank_mask:0xf bound_ctrl:0
    s_nop 1
    v_add_f32_dpp v156, v156, v156 row_bcast:15 row_mask:0xa bank_mask:0xf
    s_nop 1
    v_add_f32_dpp v156, v156, v156 row_bcast:31 row_mask:0xc bank_mask:0xf
    s_nop 1
    v_cvt_pk_bf16_f32 v157, v156, v156
    v_lshlrev_b32 v157, 16, v157
    s_mov_b32 s88, 0xbfb8aa3b
    v_mul_f32 v157, s88, v157
    v_exp_f32 v157, v157
    s_nop 0
    v_add_f32 v157, 1.0, v157
    v_rcp_f32 v157, v157
    s_nop 0
    v_cvt_pk_bf16_f32 v157, v157, v157
    v_lshlrev_b32 v160, 16, v157
    v_sub_f32 v161, 1.0, v160
    v_cvt_pk_bf16_f32 v161, v161, v161
    v_lshlrev_b32 v161, 16, v161
    v_mov_b32 v3, 2320
    v_cmp_eq_u32 vcc, 63, v1
    s_and_saveexec_b64 s[82:83], vcc
    ds_write_b64 v3, v[160:161]
    s_mov_b64 exec, s[82:83]
    s_waitcnt lgkmcnt(0)
    s_barrier
    s_lshr_b32 s78, s72, 3
    s_lshr_b32 s79, s78, 1
    s_and_b32 s80, s78, 1
    s_and_b32 s81, s72, 7
    s_lshl_b32 s81, s81, 5
    s_lshl_b32 s82, s71, 3
    s_add_u32 s82, s82, s79
    s_cmp_eq_u32 s71, 0
    s_cselect_b32 s83, 7, 26
    s_lshl_b32 s84, s82, 6
    s_add_u32 s84, s84, s80
    s_mul_i32 s84, s84, 1280
    s_add_u32 s84, s84, 65536
    s_lshl_b32 s85, s81, 2
    s_add_u32 s85, s85, s84
    v_lshrrev_b32 v28, 3, v1
    v_and_b32 v29, 7, v1
    v_add_u32 v30, 0, v28
    v_cmp_gt_u32 vcc, s83, v30
    s_nop 1
    v_cndmask_b32 v30, 0, v30, vcc
    v_mul_u32_u24 v32, 2560, v30
    v_lshl_add_u32 v32, v29, 4, v32
    v_add_u32 v30, 8, v28
    v_cmp_gt_u32 vcc, s83, v30
    s_nop 1
    v_cndmask_b32 v30, 0, v30, vcc
    v_mul_u32_u24 v33, 2560, v30
    v_lshl_add_u32 v33, v29, 4, v33
    v_add_u32 v30, 16, v28
    v_cmp_gt_u32 vcc, s83, v30
    s_nop 1
    v_cndmask_b32 v30, 0, v30, vcc
    v_mul_u32_u24 v34, 2560, v30
    v_lshl_add_u32 v34, v29, 4, v34
    v_add_u32 v30, 24, v28
    v_cmp_gt_u32 vcc, s83, v30
    s_nop 1
    v_cndmask_b32 v30, 0, v30, vcc
    v_mul_u32_u24 v35, 2560, v30
    v_lshl_add_u32 v35, v29, 4, v35
    v_cmp_gt_u32 s[86:87], s83, v1
    s_nop 1
    v_cndmask_b32 v30, 0, v1, s[86:87]
    v_mul_u32_u24 v36, 2560, v30
    s_mov_b32 s90, 0
.Lh_poll3:
    buffer_load_dwordx4 v[8:11], v32, s[32:35], s85 offen sc1
    buffer_load_dwordx4 v[12:15], v33, s[32:35], s85 offen sc1
    buffer_load_dwordx4 v[16:19], v34, s[32:35], s85 offen sc1
    buffer_load_dwordx4 v[20:23], v35, s[32:35], s85 offen sc1
    buffer_load_dwordx2 v[24:25], v36, s[32:35], s84 offen offset:1024 sc1
    s_waitcnt vmcnt(0)
    v_max3_u32 v30, v8, v9, v10
    v_max3_u32 v31, v11, v12, v13
    v_max3_u32 v30, v30, v14, v15
    v_max3_u32 v31, v31, v16, v17
    v_max3_u32 v30, v30, v18, v19
    v_max3_u32 v31, v31, v20, v21
    v_max3_u32 v30, v30, v22, v23
    v_max3_u32 v31, v31, v24, v25
    v_max_u32 v30, v30, v31
    v_cmp_eq_u32 vcc, -1, v30
    s_cbranch_vccz .Lh_got3
    s_add_u32 s90, s90, 1
    s_cmp_lt_u32 s90, 131072
    s_cbranch_scc1 .Lh_poll3
.Lh_got3:
    v_mov_b32 v37, 0xff800000
    v_cndmask_b32 v24, v37, v24, s[86:87]
    v_cndmask_b32 v25, 0, v25, s[86:87]
    v_mov_b32 v38, v24
    s_nop 1
    v_max_f32_dpp v38, v38, v38 row_shr:1 row_mask:0xf bank_mask:0xf
    s_nop 1
    v_max_f32_dpp v38, v38, v38 row_shr:2 row_mask:0xf bank_mask:0xf
    s_nop 1
    v_max_f32_dpp v38, v38, v38 row_shr:4 row_mask:0xf bank_mask:0xf
    s_nop 1
    v_max_f32_dpp v38, v38, v38 row_shr:8 row_mask:0xf bank_mask:0xf
    s_nop 1
    v_max_f32_dpp v38, v38, v38 row_bcast:15 row_mask:0xa bank_mask:0xf
    s_nop 1
    v_max_f32_dpp v38, v38, v38 row_bcast:31 row_mask:0xc bank_mask:0xf
    s_nop 1
    v_readlane_b32 s88, v38, 63
    s_nop 3
    v_subrev_f32 v38, s88, v24
    v_exp_f32 v38, v38
    s_nop 0
    v_mul_f32 v39, v38, v25
    s_nop 1
    v_add_f32_dpp v39, v39, v39 row_shr:1 row_mask:0xf bank_mask:0xf bound_ctrl:0
    s_nop 1
    v_add_f32_dpp v39, v39, v39 row_shr:2 row_mask:0xf bank_mask:0xf bound_ctrl:0
    s_nop 1
    v_add_f32_dpp v39, v39, v39 row_shr:4 row_mask:0xf bank_mask:0xf bound_ctrl:0
    s_nop 1
    v_add_f32_dpp v39, v39, v39 row_shr:8 row_mask:0xf bank_mask:0xf bound_ctrl:0
    s_nop 1
    v_add_f32_dpp v39, v39, v39 row_bcast:15 row_mask:0xa bank_mask:0xf
    s_nop 1
    v_add_f32_dpp v39, v39, v39 row_bcast:31 row_mask:0xc bank_mask:0xf
    s_nop 1
    v_readlane_b32 s89, v39, 63
    v_lshlrev_b32 v40, 2, v28
    v_add_u32 v41, 32, v40
    v_add_u32 v42, 64, v40
    v_add_u32 v43, 96, v40
    v_rcp_f32 v39, s89
    s_nop 0
    v_mul_f32 v38, v38, v39
    s_nop 1
    ds_bpermute_b32 v44, v40, v38
    ds_bpermute_b32 v45, v41, v38
    ds_bpermute_b32 v46, v42, v38
    ds_bpermute_b32 v47, v43, v38
    s_waitcnt lgkmcnt(0)
    v_mul_f32 v48, v44, v8
    v_mul_f32 v49, v44, v9
    v_mul_f32 v50, v44, v10
    v_mul_f32 v51, v44, v11
    v_fmac_f32 v48, v45, v12
    v_fmac_f32 v49, v45, v13
    v_fmac_f32 v50, v45, v14
    v_fmac_f32 v51, v45, v15
    v_fmac_f32 v48, v46, v16
    v_fmac_f32 v49, v46, v17
    v_fmac_f32 v50, v46, v18
    v_fmac_f32 v51, v46, v19
    v_fmac_f32 v48, v47, v20
    v_fmac_f32 v49, v47, v21
    v_fmac_f32 v50, v47, v22
    v_fmac_f32 v51, v47, v23
    s_nop 1
    v_add_f32_dpp v48, v48, v48 row_ror:8 row_mask:0xf bank_mask:0x3
    v_add_f32_dpp v50, v50, v50 row_ror:8 row_mask:0xf bank_mask:0x3
    v_add_f32_dpp v48, v49, v49 row_ror:8 row_mask:0xf bank_mask:0xc
    v_add_f32_dpp v50, v51, v51 row_ror:8 row_mask:0xf bank_mask:0xc
    s_nop 1
    v_permlane16_swap_b32 v48, v50
    v_add_f32 v48, v48, v50
    v_mov_b32 v49, v48
    s_nop 1
    v_permlane32_swap_b32 v48, v49
    v_add_f32 v48, v48, v49
    v_cvt_pk_bf16_f32 v48, v48, 0
    v_and_b32 v49, 3, v28
    v_lshl_add_u32 v49, v29, 2, v49
    v_lshlrev_b32 v49, 2, v49
    ds_write_b32 v49, v48 offset:2432
    s_waitcnt lgkmcnt(0)
    s_setprio 0
    s_barrier
    s_barrier
    s_cmp_ge_u32 s2, 28
    s_cbranch_scc1 .Lend
    s_barrier
.Lend:
.Lexit:
    s_endpgm
.section .rodata,"a"
.p2align 6
.amdhsa_kernel gated_mix__sliding_block_cached__gqa_block_cached__decode_kernel
  .amdhsa_next_free_vgpr 168
  .amdhsa_next_free_sgpr 102
  .amdhsa_accum_offset 168
  .amdhsa_group_segment_fixed_size 0
  .amdhsa_kernarg_size 112
  .amdhsa_user_sgpr_count 2
  .amdhsa_user_sgpr_kernarg_segment_ptr 1
  .amdhsa_system_sgpr_workgroup_id_x 1
.end_amdhsa_kernel
.text
```
